```python
import torch

def _softmax(x, axis=-1):
    return torch.softmax(x, dim=axis)
def _gelu(x):
    return torch.nn.functional.gelu(x, approximate="tanh")
def _silu(x):
    return torch.nn.functional.silu(x)
def _sigmoid(x):
    return torch.sigmoid(x)
def _layernorm(x, axis=-1, eps=1e-5):
    m = x.mean(dim=axis, keepdim=True)
    v = x.var(dim=axis, keepdim=True, unbiased=False)
    return (x - m) / torch.sqrt(v + eps)
def _scatter_add(tgt, idx, src, axis=0):
    return tgt.clone().index_add_(axis, idx, src)
def _segment_sum(src, seg, n):
    out = torch.zeros((n,) + src.shape[1:], dtype=src.dtype)
    return out.index_add_(0, seg, src)
def _pad(x, pw):
    flat = tuple(v for pair in reversed(pw) for v in pair)
    return torch.nn.functional.pad(x, flat)

kernel_name = 'concat_heads__mha_block_cached__mha_block_cached__near_ridge'

def setup_inputs():

    _w = (lambda a: (lambda t: t.to(torch.bfloat16) if t.is_floating_point() else t)(torch.as_tensor(a)))
    def _A_setup():
        B, Sq, D = 8, 96, 640
        H, Sk, Dh = 32, 512, 128
        return {
            "x": _w((lambda *s: torch.randn(*s, dtype=torch.bfloat16) * 0.8)(B, Sq, D)),
            "k_cache": _w((lambda *s: torch.randn(*s, dtype=torch.bfloat16) * 0.8)(B, H, Sk, Dh)),
            "v_cache": _w((lambda *s: torch.randn(*s, dtype=torch.bfloat16) * 0.05)(B, H, Sk, Dh)),
            "wq": _w((lambda *s: torch.randn(*s, dtype=torch.bfloat16) * 0.8)(D, H * Dh) * (D ** -0.5)),
            "wo": _w((lambda *s: torch.randn(*s, dtype=torch.bfloat16) * 0.05)(H * Dh, D) * ((H * Dh) ** -0.5)),
        }
    _A_in = _A_setup()

    def _B_setup():
        B, Sq, D = 8, 96, 640
        H, Sk, Dh = 32, 512, 128
        return {
            "x": _w((lambda *s: torch.randn(*s, dtype=torch.bfloat16) * 0.8)(B, Sq, D)),
            "k_cache": _w((lambda *s: torch.randn(*s, dtype=torch.bfloat16) * 0.8)(B, H, Sk, Dh)),
            "v_cache": _w((lambda *s: torch.randn(*s, dtype=torch.bfloat16) * 0.05)(B, H, Sk, Dh)),
            "wq": _w((lambda *s: torch.randn(*s, dtype=torch.bfloat16) * 0.8)(D, H * Dh) * (D ** -0.5)),
            "wo": _w((lambda *s: torch.randn(*s, dtype=torch.bfloat16) * 0.05)(H * Dh, D) * ((H * Dh) ** -0.5)),
        }
    _B_in = _B_setup()

    return {
        "A_x": _A_in["x"],
        "A_k_cache": _A_in["k_cache"],
        "A_v_cache": _A_in["v_cache"],
        "A_wq": _A_in["wq"],
        "A_wo": _A_in["wo"],
        "B_x": _B_in["x"],
        "B_k_cache": _B_in["k_cache"],
        "B_v_cache": _B_in["v_cache"],
        "B_wq": _B_in["wq"],
        "B_wo": _B_in["wo"],
    }

def reference(A_x, A_k_cache, A_v_cache, A_wq, A_wo, B_x, B_k_cache, B_v_cache, B_wq, B_wo):
    def _A_ref(x, k_cache, v_cache, wq, wo):
        B, Sq, D = x.shape
        H, Dh = 32, 128
        q = (lambda x, *d: x.permute(*d))((x @ wq).reshape(B, Sq, H, Dh), 0, 2, 1, 3)
        scores = torch.einsum("bhqd,bhkd->bhqk", q, k_cache) * (Dh ** -0.5)
        p = _softmax(scores, axis=-1)
        o = torch.einsum("bhqk,bhkd->bhqd", p, v_cache)
        return (lambda x, *d: x.permute(*d))(o, 0, 2, 1, 3).reshape(B, Sq, H * Dh) @ wo

    def _B_ref(x, k_cache, v_cache, wq, wo):
        B, Sq, D = x.shape
        H, Dh = 32, 128
        q = (lambda x, *d: x.permute(*d))((x @ wq).reshape(B, Sq, H, Dh), 0, 2, 1, 3)
        scores = torch.einsum("bhqd,bhkd->bhqk", q, k_cache) * (Dh ** -0.5)
        p = _softmax(scores, axis=-1)
        o = torch.einsum("bhqk,bhkd->bhqd", p, v_cache)
        return (lambda x, *d: x.permute(*d))(o, 0, 2, 1, 3).reshape(B, Sq, H * Dh) @ wo

    a = _A_ref(A_x, A_k_cache, A_v_cache, A_wq, A_wo)
    b = _B_ref(B_x, B_k_cache, B_v_cache, B_wq, B_wo)
    return torch.concatenate([a, b], axis=-1)
```

```asm
; @launch grid=(256,1,1) block=(256,1,1) lds=163840
.amdgcn_target "amdgcn-amd-amdhsa--gfx950"
.text
.globl concat_heads__mha_block_cached__mha_block_cached__near_ridge_kernel
.p2align 8
.type concat_heads__mha_block_cached__mha_block_cached__near_ridge_kernel,@function
concat_heads__mha_block_cached__mha_block_cached__near_ridge_kernel:
    s_cmp_ge_u32 s2, 256
    s_cbranch_scc1 L_END
    s_load_dwordx16 s[40:55], s[0:1], 0
    s_load_dwordx4 s[56:59], s[0:1], 64
    s_load_dwordx4 s[60:63], s[0:1], 80
    s_load_dwordx2 s[64:65], s[0:1], 96
    v_lshrrev_b32 v1, 6, v0
    s_and_b32 s36, s2, 7
    v_readfirstlane_b32 s3, v1
    s_lshr_b32 s32, s36, 2
    s_and_b32 s33, s36, 3
    s_lshr_b32 s36, s2, 3
    s_lshr_b32 s34, s36, 2
    s_and_b32 s35, s36, 3
    v_and_b32 v1, 63, v0
    s_cmp_lg_u32 s3, 3
    s_cbranch_scc1 L_compute
    v_lshrrev_b32 v2, 4, v1
    v_and_b32 v3, 15, v1
    v_lshlrev_b32 v4, 2, v2
    v_xor_b32 v4, v4, v3
    v_lshlrev_b32 v4, 4, v4
    v_lshl_add_u32 v20, v2, 8, v4
    v_lshlrev_b32 v5, 13, v2
    v_add_u32 v5, v5, v4
    v_add_u32 v24, 0, v5
    v_add_u32 v25, 31744, v5
    v_add_u32 v26, 63488, v5
    v_add_u32 v27, 95232, v5
    v_lshrrev_b32 v6, 3, v1
    v_and_b32 v7, 7, v1
    s_movk_i32 s36, 1280
    v_mul_lo_u32 v6, v6, s36
    v_add_u32 v8, 0, v2
    v_xor_b32 v8, v8, v7
    v_lshl_add_u32 v8, v8, 4, v6
    v_add_u32 v28, 0, v8
    v_add_u32 v8, 4, v2
    v_xor_b32 v8, v8, v7
    v_lshl_add_u32 v8, v8, 4, v6
    v_add_u32 v29, 9216, v8
    v_add_u32 v8, 0, v2
    v_xor_b32 v8, v8, v7
    v_lshl_add_u32 v8, v8, 4, v6
    v_add_u32 v30, 18432, v8
    v_add_u32 v8, 4, v2
    v_xor_b32 v8, v8, v7
    v_lshl_add_u32 v8, v8, 4, v6
    v_add_u32 v31, 27648, v8
    v_mov_b32 v38, 0
    s_lshl_b32 s70, s33, 3
    s_add_u32 s70, s70, s35
    s_mul_i32 s69, s34, 122880
    s_mul_i32 s38, s35, 5
    s_lshr_b32 s38, s38, 1
    s_add_u32 s78, s38, s34
    s_cmp_ge_u32 s78, 10
    s_cselect_b32 s38, 10, 0
    s_sub_u32 s78, s78, s38
    s_getpc_b64 s[72:73]
L_pc_ref0:
    s_sub_u32 s72, s72, L_pc_ref0-concat_heads__mha_block_cached__mha_block_cached__near_ridge_kernel
    s_subb_u32 s73, s73, 0
    s_lshl_b32 s37, s34, 2
    s_add_u32 s37, s37, s35
    s_mul_i32 s37, s37, 1152
    v_lshlrev_b32 v47, 7, v1
    v_add_u32 v48, s37, v47
    s_mov_b32 s37, L_compute-concat_heads__mha_block_cached__mha_block_cached__near_ridge_kernel-1152
    v_add_u32 v47, s37, v47
    v_cmp_gt_u32 vcc, 9, v1
    s_nop 1
    v_cndmask_b32 v47, v47, v48, vcc
    s_mov_b32 exec_lo, 0xffffffff
    s_mov_b32 exec_hi, 0x1ffffff
    global_load_dword v53, v47, s[72:73]
    s_mov_b64 exec, -1
    s_waitcnt lgkmcnt(0)
    s_cmp_eq_u32 s32, 0
    s_cselect_b32 s16, s40, s50
    s_cselect_b32 s17, s41, s51
    s_cselect_b32 s12, s46, s56
    s_cselect_b32 s13, s47, s57
    s_cselect_b32 s4, s42, s52
    s_cselect_b32 s5, s43, s53
    s_cselect_b32 s8, s44, s54
    s_cselect_b32 s9, s45, s55
    s_cselect_b32 s20, s48, s58
    s_cselect_b32 s21, s49, s59
    s_mov_b32 s18, 983040
    s_mov_b32 s19, 0x20000
    s_and_b32 s17, s17, 0xffff
    s_mov_b32 s14, 5242880
    s_mov_b32 s15, 0x20000
    s_and_b32 s13, s13, 0xffff
    s_add_u32 s68, s78, 0
    s_cmp_ge_u32 s68, 10
    s_cselect_b32 s38, 10, 0
    s_sub_u32 s68, s68, s38
    s_lshl_b32 s79, s68, 7
    s_add_u32 s79, s79, s69
    s_mov_b32 s80, 81920
    s_add_u32 m0, s80, 0
    s_add_u32 s36, s79, 0
    buffer_load_dwordx4 v28, s[16:19], s36 offen offset:0 lds
    buffer_load_dwordx4 v29, s[16:19], s36 offen offset:1024 lds
    buffer_load_dwordx4 v30, s[16:19], s36 offen offset:2048 lds
    buffer_load_dwordx4 v31, s[16:19], s36 offen offset:3072 lds
    s_add_u32 m0, s80, 4096
    s_add_u32 s36, s79, 40960
    buffer_load_dwordx4 v28, s[16:19], s36 offen offset:0 lds
    buffer_load_dwordx4 v29, s[16:19], s36 offen offset:1024 lds
    buffer_load_dwordx4 v30, s[16:19], s36 offen offset:2048 lds
    buffer_load_dwordx4 v31, s[16:19], s36 offen offset:3072 lds
    s_add_u32 m0, s80, 8192
    s_add_u32 s36, s79, 81920
    buffer_load_dwordx4 v28, s[16:19], s36 offen offset:0 lds
    buffer_load_dwordx4 v29, s[16:19], s36 offen offset:1024 lds
    buffer_load_dwordx4 v30, s[16:19], s36 offen offset:2048 lds
    buffer_load_dwordx4 v31, s[16:19], s36 offen offset:3072 lds
    s_lshl_b32 s79, s68, 19
    s_lshl_b32 s38, s70, 8
    s_add_u32 s79, s79, s38
    s_mov_b32 s80, 65536
    s_add_u32 m0, s80, 0
    s_add_u32 s36, s79, 0
    buffer_load_dwordx4 v24, s[12:15], s36 offen offset:0 lds
    buffer_load_dwordx4 v25, s[12:15], s36 offen offset:1024 lds
    buffer_load_dwordx4 v26, s[12:15], s36 offen offset:2048 lds
    buffer_load_dwordx4 v27, s[12:15], s36 offen offset:3072 lds
    s_add_u32 m0, s80, 4096
    s_add_u32 s36, s79, 131072
    buffer_load_dwordx4 v24, s[12:15], s36 offen offset:0 lds
    buffer_load_dwordx4 v25, s[12:15], s36 offen offset:1024 lds
    buffer_load_dwordx4 v26, s[12:15], s36 offen offset:2048 lds
    buffer_load_dwordx4 v27, s[12:15], s36 offen offset:3072 lds
    s_add_u32 m0, s80, 8192
    s_add_u32 s36, s79, 262144
    buffer_load_dwordx4 v24, s[12:15], s36 offen offset:0 lds
    buffer_load_dwordx4 v25, s[12:15], s36 offen offset:1024 lds
    buffer_load_dwordx4 v26, s[12:15], s36 offen offset:2048 lds
    buffer_load_dwordx4 v27, s[12:15], s36 offen offset:3072 lds
    s_add_u32 m0, s80, 12288
    s_add_u32 s36, s79, 393216
    buffer_load_dwordx4 v24, s[12:15], s36 offen offset:0 lds
    buffer_load_dwordx4 v25, s[12:15], s36 offen offset:1024 lds
    buffer_load_dwordx4 v26, s[12:15], s36 offen offset:2048 lds
    buffer_load_dwordx4 v27, s[12:15], s36 offen offset:3072 lds
    s_add_u32 s68, s78, 1
    s_cmp_ge_u32 s68, 10
    s_cselect_b32 s38, 10, 0
    s_sub_u32 s68, s68, s38
    s_lshl_b32 s79, s68, 7
    s_add_u32 s79, s79, s69
    s_mov_b32 s80, 114688
    s_add_u32 m0, s80, 0
    s_add_u32 s36, s79, 0
    buffer_load_dwordx4 v28, s[16:19], s36 offen offset:0 lds
    buffer_load_dwordx4 v29, s[16:19], s36 offen offset:1024 lds
    buffer_load_dwordx4 v30, s[16:19], s36 offen offset:2048 lds
    buffer_load_dwordx4 v31, s[16:19], s36 offen offset:3072 lds
    s_add_u32 m0, s80, 4096
    s_add_u32 s36, s79, 40960
    buffer_load_dwordx4 v28, s[16:19], s36 offen offset:0 lds
    buffer_load_dwordx4 v29, s[16:19], s36 offen offset:1024 lds
    buffer_load_dwordx4 v30, s[16:19], s36 offen offset:2048 lds
    buffer_load_dwordx4 v31, s[16:19], s36 offen offset:3072 lds
    s_add_u32 m0, s80, 8192
    s_add_u32 s36, s79, 81920
    buffer_load_dwordx4 v28, s[16:19], s36 offen offset:0 lds
    buffer_load_dwordx4 v29, s[16:19], s36 offen offset:1024 lds
    buffer_load_dwordx4 v30, s[16:19], s36 offen offset:2048 lds
    buffer_load_dwordx4 v31, s[16:19], s36 offen offset:3072 lds
    s_lshl_b32 s79, s68, 19
    s_lshl_b32 s38, s70, 8
    s_add_u32 s79, s79, s38
    s_mov_b32 s80, 98304
    s_add_u32 m0, s80, 0
    s_add_u32 s36, s79, 0
    buffer_load_dwordx4 v24, s[12:15], s36 offen offset:0 lds
    buffer_load_dwordx4 v25, s[12:15], s36 offen offset:1024 lds
    buffer_load_dwordx4 v26, s[12:15], s36 offen offset:2048 lds
    buffer_load_dwordx4 v27, s[12:15], s36 offen offset:3072 lds
    s_add_u32 m0, s80, 4096
    s_add_u32 s36, s79, 131072
    buffer_load_dwordx4 v24, s[12:15], s36 offen offset:0 lds
    buffer_load_dwordx4 v25, s[12:15], s36 offen offset:1024 lds
    buffer_load_dwordx4 v26, s[12:15], s36 offen offset:2048 lds
    buffer_load_dwordx4 v27, s[12:15], s36 offen offset:3072 lds
    s_add_u32 m0, s80, 8192
    s_add_u32 s36, s79, 262144
    buffer_load_dwordx4 v24, s[12:15], s36 offen offset:0 lds
    buffer_load_dwordx4 v25, s[12:15], s36 offen offset:1024 lds
    buffer_load_dwordx4 v26, s[12:15], s36 offen offset:2048 lds
    buffer_load_dwordx4 v27, s[12:15], s36 offen offset:3072 lds
    s_add_u32 m0, s80, 12288
    s_add_u32 s36, s79, 393216
    buffer_load_dwordx4 v24, s[12:15], s36 offen offset:0 lds
    buffer_load_dwordx4 v25, s[12:15], s36 offen offset:1024 lds
    buffer_load_dwordx4 v26, s[12:15], s36 offen offset:2048 lds
    buffer_load_dwordx4 v27, s[12:15], s36 offen offset:3072 lds
    s_mov_b32 s6, 33554432
    s_mov_b32 s7, 0x20000
    s_and_b32 s5, s5, 0xffff
    s_mov_b32 s10, 33554432
    s_mov_b32 s11, 0x20000
    s_and_b32 s9, s9, 0xffff
    s_mov_b32 s22, 5242880
    s_mov_b32 s23, 0x20000
    s_and_b32 s21, s21, 0xffff
    s_mov_b32 s28, s60
    s_and_b32 s29, s61, 0xffff
    s_mov_b32 s30, 1966080
    s_mov_b32 s31, 0x20000
    s_mov_b32 s24, s64
    s_and_b32 s25, s65, 0xffff
    s_mov_b32 s26, 268435456
    s_mov_b32 s27, 0x20000
    s_lshl_b32 s64, s32, 2
    s_add_u32 s64, s64, s33
    s_lshl_b32 s64, s64, 3
    s_add_u32 s64, s64, s34
    s_lshl_b32 s64, s64, 7
    s_add_u32 s64, s64, 41943040
    s_lshl_b32 s65, s32, 3
    s_add_u32 s65, s65, s34
    s_lshl_b32 s65, s65, 2
    s_add_u32 s65, s65, s35
    s_lshl_b32 s65, s65, 7
    s_add_u32 s65, s65, 41975808
    s_lshl_b32 s47, s35, 1
    s_add_u32 s47, s47, s34
    s_add_u32 s47, s47, s33
    s_lshl_b32 s38, s34, 5
    s_add_u32 s42, s38, s70
    s_lshl_b32 s42, s42, 17
    s_add_u32 s43, s42, 524288
    s_mul_i32 s45, s33, 1310720
    s_mul_i32 s37, s35, 320
    s_add_u32 s45, s45, s37
    s_lshl_b32 s46, s32, 3
    s_add_u32 s46, s46, s34
    s_lshl_b32 s46, s46, 5
    s_lshl_b32 s37, s33, 3
    s_add_u32 s46, s46, s37
    s_mul_i32 s46, s46, 24576
    s_cmp_eq_u32 s2, 0
    s_cbranch_scc0 L_nonce_skip
    s_memrealtime s[50:51]
    s_waitcnt lgkmcnt(0)
    s_or_b32 s50, s50, 1
    v_mov_b32 v44, s50
    s_mov_b64 exec, 1
    global_store_dword v38, v44, s[62:63] sc0 sc1
    s_mov_b64 exec, -1
    s_waitcnt vmcnt(0)
L_nonce_skip:
    v_lshrrev_b32 v2, 4, v1
    v_and_b32 v3, 15, v1
    v_add_u32 v4, 0, v2
    v_xor_b32 v4, v4, v3
    v_lshlrev_b32 v4, 4, v4
    v_lshl_add_u32 v16, v2, 8, v4
    v_add_u32 v4, 4, v2
    v_xor_b32 v4, v4, v3
    v_lshlrev_b32 v4, 4, v4
    v_lshl_add_u32 v17, v2, 8, v4
    v_add_u32 v4, 8, v2
    v_xor_b32 v4, v4, v3
    v_lshlrev_b32 v4, 4, v4
    v_lshl_add_u32 v18, v2, 8, v4
    v_add_u32 v4, 12, v2
    v_xor_b32 v4, v4, v3
    v_lshlrev_b32 v4, 4, v4
    v_lshl_add_u32 v19, v2, 8, v4
    s_movk_i32 s36, 3277
    v_add_u32 v2, 0, v1
    v_mul_lo_u32 v3, v2, s36
    v_lshrrev_b32 v3, 16, v3
    v_mul_u32_u24 v4, 20, v3
    v_sub_u32 v4, v2, v4
    v_mul_u32_u24 v3, 1280, v3
    v_lshl_add_u32 v3, v4, 4, v3
    v_subrev_u32 v32, 0, v3
    v_add_u32 v2, 64, v1
    v_mul_lo_u32 v3, v2, s36
    v_lshrrev_b32 v3, 16, v3
    v_mul_u32_u24 v4, 20, v3
    v_sub_u32 v4, v2, v4
    v_mul_u32_u24 v3, 1280, v3
    v_lshl_add_u32 v3, v4, 4, v3
    v_subrev_u32 v33, 1024, v3
    v_add_u32 v2, 128, v1
    v_mul_lo_u32 v3, v2, s36
    v_lshrrev_b32 v3, 16, v3
    v_mul_u32_u24 v4, 20, v3
    v_sub_u32 v4, v2, v4
    v_mul_u32_u24 v3, 1280, v3
    v_lshl_add_u32 v3, v4, 4, v3
    v_subrev_u32 v34, 2048, v3
    v_add_u32 v2, 192, v1
    v_mul_lo_u32 v3, v2, s36
    v_lshrrev_b32 v3, 16, v3
    v_mul_u32_u24 v4, 20, v3
    v_sub_u32 v4, v2, v4
    v_mul_u32_u24 v3, 1280, v3
    v_lshl_add_u32 v3, v4, 4, v3
    v_subrev_u32 v35, 3072, v3
    v_add_u32 v2, 256, v1
    v_mul_lo_u32 v3, v2, s36
    v_lshrrev_b32 v3, 16, v3
    v_mul_u32_u24 v4, 20, v3
    v_sub_u32 v4, v2, v4
    v_mul_u32_u24 v3, 1280, v3
    v_lshl_add_u32 v3, v4, 4, v3
    v_mov_b32 v36, v3
    v_lshlrev_b32 v37, 4, v1
    v_lshlrev_b32 v39, 2, v1
    v_cmp_gt_u32 vcc, 12, v1
    s_nop 1
    v_cndmask_b32 v39, 0, v39, vcc
    s_waitcnt vmcnt(28)
    s_barrier
    s_add_u32 s68, s78, 2
    s_cmp_ge_u32 s68, 10
    s_cselect_b32 s38, 10, 0
    s_sub_u32 s68, s68, s38
    s_lshl_b32 s79, s68, 7
    s_add_u32 s79, s79, s69
    s_mov_b32 s80, 147456
    s_call_b64 s[66:67], L_ldx
    s_lshl_b32 s79, s68, 19
    s_lshl_b32 s38, s70, 8
    s_add_u32 s79, s79, s38
    s_mov_b32 s80, 131072
    s_call_b64 s[66:67], L_ldwq
    s_waitcnt vmcnt(28)
    s_barrier
    s_add_u32 s68, s78, 3
    s_cmp_ge_u32 s68, 10
    s_cselect_b32 s38, 10, 0
    s_sub_u32 s68, s68, s38
    s_lshl_b32 s79, s68, 7
    s_add_u32 s79, s79, s69
    s_mov_b32 s80, 81920
    s_call_b64 s[66:67], L_ldx
    s_lshl_b32 s79, s68, 19
    s_lshl_b32 s38, s70, 8
    s_add_u32 s79, s79, s38
    s_mov_b32 s80, 65536
    s_call_b64 s[66:67], L_ldwq
    s_waitcnt vmcnt(28)
    s_barrier
    s_add_u32 s68, s78, 4
    s_cmp_ge_u32 s68, 10
    s_cselect_b32 s38, 10, 0
    s_sub_u32 s68, s68, s38
    s_lshl_b32 s79, s68, 7
    s_add_u32 s79, s79, s69
    s_mov_b32 s80, 114688
    s_call_b64 s[66:67], L_ldx
    s_lshl_b32 s79, s68, 19
    s_lshl_b32 s38, s70, 8
    s_add_u32 s79, s79, s38
    s_mov_b32 s80, 98304
    s_call_b64 s[66:67], L_ldwq
    s_waitcnt vmcnt(28)
    s_barrier
    s_add_u32 s68, s78, 5
    s_cmp_ge_u32 s68, 10
    s_cselect_b32 s38, 10, 0
    s_sub_u32 s68, s68, s38
    s_lshl_b32 s79, s68, 7
    s_add_u32 s79, s79, s69
    s_mov_b32 s80, 147456
    s_call_b64 s[66:67], L_ldx
    s_lshl_b32 s79, s68, 19
    s_lshl_b32 s38, s70, 8
    s_add_u32 s79, s79, s38
    s_mov_b32 s80, 131072
    s_call_b64 s[66:67], L_ldwq
    s_waitcnt vmcnt(28)
    s_barrier
    s_add_u32 s68, s78, 6
    s_cmp_ge_u32 s68, 10
    s_cselect_b32 s38, 10, 0
    s_sub_u32 s68, s68, s38
    s_lshl_b32 s79, s68, 7
    s_add_u32 s79, s79, s69
    s_mov_b32 s80, 81920
    s_call_b64 s[66:67], L_ldx
    s_lshl_b32 s79, s68, 19
    s_lshl_b32 s38, s70, 8
    s_add_u32 s79, s79, s38
    s_mov_b32 s80, 65536
    s_call_b64 s[66:67], L_ldwq
    s_waitcnt vmcnt(28)
    s_barrier
    s_add_u32 s68, s78, 7
    s_cmp_ge_u32 s68, 10
    s_cselect_b32 s38, 10, 0
    s_sub_u32 s68, s68, s38
    s_lshl_b32 s79, s68, 7
    s_add_u32 s79, s79, s69
    s_mov_b32 s80, 114688
    s_call_b64 s[66:67], L_ldx
    s_lshl_b32 s79, s68, 19
    s_lshl_b32 s38, s70, 8
    s_add_u32 s79, s79, s38
    s_mov_b32 s80, 98304
    s_call_b64 s[66:67], L_ldwq
    s_waitcnt vmcnt(28)
    s_barrier
    s_add_u32 s68, s78, 8
    s_cmp_ge_u32 s68, 10
    s_cselect_b32 s38, 10, 0
    s_sub_u32 s68, s68, s38
    s_lshl_b32 s79, s68, 7
    s_add_u32 s79, s79, s69
    s_mov_b32 s80, 147456
    s_call_b64 s[66:67], L_ldx
    s_lshl_b32 s79, s68, 19
    s_lshl_b32 s38, s70, 8
    s_add_u32 s79, s79, s38
    s_mov_b32 s80, 131072
    s_call_b64 s[66:67], L_ldwq
    s_waitcnt vmcnt(28)
    s_barrier
    s_add_u32 s68, s78, 9
    s_cmp_ge_u32 s68, 10
    s_cselect_b32 s38, 10, 0
    s_sub_u32 s68, s68, s38
    s_lshl_b32 s79, s68, 7
    s_add_u32 s79, s79, s69
    s_mov_b32 s80, 81920
    s_call_b64 s[66:67], L_ldx
    s_lshl_b32 s79, s68, 19
    s_lshl_b32 s38, s70, 8
    s_add_u32 s79, s79, s38
    s_mov_b32 s80, 65536
    s_call_b64 s[66:67], L_ldwq
    s_waitcnt vmcnt(28)
    s_barrier
    s_add_u32 s68, s78, 0
    s_cmp_ge_u32 s68, 10
    s_cselect_b32 s38, 10, 0
    s_sub_u32 s68, s68, s38
    s_lshl_b32 s79, s68, 7
    s_add_u32 s79, s79, s69
    s_mov_b32 s80, 114688
    s_call_b64 s[66:67], L_ldx
    s_lshl_b32 s79, s68, 19
    s_lshl_b32 s38, s70, 8
    s_add_u32 s79, s79, s38
    s_add_u32 s79, s79, 1024
    s_mov_b32 s80, 98304
    s_call_b64 s[66:67], L_ldwq
    s_waitcnt vmcnt(28)
    s_barrier
    s_add_u32 s68, s78, 1
    s_cmp_ge_u32 s68, 10
    s_cselect_b32 s38, 10, 0
    s_sub_u32 s68, s68, s38
    s_lshl_b32 s79, s68, 7
    s_add_u32 s79, s79, s69
    s_mov_b32 s80, 147456
    s_call_b64 s[66:67], L_ldx
    s_lshl_b32 s79, s68, 19
    s_lshl_b32 s38, s70, 8
    s_add_u32 s79, s79, s38
    s_add_u32 s79, s79, 1024
    s_mov_b32 s80, 131072
    s_call_b64 s[66:67], L_ldwq
    s_waitcnt vmcnt(0)
    s_barrier
    s_add_u32 s79, s47, 0
    s_and_b32 s79, s79, 7
    s_lshl_b32 s79, s79, 14
    s_add_u32 s79, s79, s42
    s_mov_b32 s80, 0
    s_call_b64 s[66:67], L_ldk
    s_add_u32 s79, s47, 1
    s_and_b32 s79, s79, 7
    s_lshl_b32 s79, s79, 14
    s_add_u32 s79, s79, s42
    s_mov_b32 s80, 32768
    s_call_b64 s[66:67], L_ldk
    s_add_u32 s79, s47, 0
    s_and_b32 s79, s79, 7
    s_lshl_b32 s79, s79, 14
    s_add_u32 s79, s79, s42
    s_mov_b32 s80, 49152
    s_call_b64 s[66:67], L_ldv
    s_waitcnt vmcnt(32)
    s_barrier
    s_add_u32 s68, s78, 2
    s_cmp_ge_u32 s68, 10
    s_cselect_b32 s38, 10, 0
    s_sub_u32 s68, s68, s38
    s_lshl_b32 s79, s68, 7
    s_add_u32 s79, s79, s69
    s_mov_b32 s80, 114688
    s_call_b64 s[66:67], L_ldx
    s_lshl_b32 s79, s68, 19
    s_lshl_b32 s38, s70, 8
    s_add_u32 s79, s79, s38
    s_add_u32 s79, s79, 1024
    s_mov_b32 s80, 98304
    s_call_b64 s[66:67], L_ldwq
    s_add_u32 s68, s78, 3
    s_cmp_ge_u32 s68, 10
    s_cselect_b32 s38, 10, 0
    s_sub_u32 s68, s68, s38
    s_lshl_b32 s79, s68, 7
    s_add_u32 s79, s79, s69
    s_mov_b32 s80, 147456
    s_call_b64 s[66:67], L_ldx
    s_lshl_b32 s79, s68, 19
    s_lshl_b32 s38, s70, 8
    s_add_u32 s79, s79, s38
    s_add_u32 s79, s79, 1024
    s_mov_b32 s80, 131072
    s_call_b64 s[66:67], L_ldwq
    s_add_u32 s79, s47, 2
    s_and_b32 s79, s79, 7
    s_lshl_b32 s79, s79, 14
    s_add_u32 s79, s79, s42
    s_mov_b32 s80, 65536
    s_call_b64 s[66:67], L_ldk
    s_add_u32 s79, s47, 1
    s_and_b32 s79, s79, 7
    s_lshl_b32 s79, s79, 14
    s_add_u32 s79, s79, s42
    s_mov_b32 s80, 81920
    s_call_b64 s[66:67], L_ldv
    s_waitcnt vmcnt(60)
    s_barrier
    s_add_u32 s79, s47, 3
    s_and_b32 s79, s79, 7
    s_lshl_b32 s79, s79, 14
    s_add_u32 s79, s79, s42
    s_mov_b32 s80, 0
    s_call_b64 s[66:67], L_ldk
    s_add_u32 s79, s47, 2
    s_and_b32 s79, s79, 7
    s_lshl_b32 s79, s79, 14
    s_add_u32 s79, s79, s42
    s_mov_b32 s80, 16384
    s_call_b64 s[66:67], L_ldv
    s_waitcnt vmcnt(32)
    s_barrier
    s_add_u32 s68, s78, 4
    s_cmp_ge_u32 s68, 10
    s_cselect_b32 s38, 10, 0
    s_sub_u32 s68, s68, s38
    s_lshl_b32 s79, s68, 7
    s_add_u32 s79, s79, s69
    s_mov_b32 s80, 114688
    s_call_b64 s[66:67], L_ldx
    s_lshl_b32 s79, s68, 19
    s_lshl_b32 s38, s70, 8
    s_add_u32 s79, s79, s38
    s_add_u32 s79, s79, 1024
    s_mov_b32 s80, 98304
    s_call_b64 s[66:67], L_ldwq
    global_load_dword v46, v38, s[62:63] sc0 sc1
    s_add_u32 s79, s47, 4
    s_and_b32 s79, s79, 7
    s_lshl_b32 s79, s79, 14
    s_add_u32 s79, s79, s42
    s_mov_b32 s80, 32768
    s_call_b64 s[66:67], L_ldk
    s_add_u32 s79, s47, 3
    s_and_b32 s79, s79, 7
    s_lshl_b32 s79, s79, 14
    s_add_u32 s79, s79, s42
    s_mov_b32 s80, 49152
    s_call_b64 s[66:67], L_ldv
    s_waitcnt vmcnt(33)
    s_barrier
    s_add_u32 s68, s78, 5
    s_cmp_ge_u32 s68, 10
    s_cselect_b32 s38, 10, 0
    s_sub_u32 s68, s68, s38
    s_lshl_b32 s79, s68, 7
    s_add_u32 s79, s79, s69
    s_mov_b32 s80, 147456
    s_call_b64 s[66:67], L_ldx
    s_lshl_b32 s79, s68, 19
    s_lshl_b32 s38, s70, 8
    s_add_u32 s79, s79, s38
    s_add_u32 s79, s79, 1024
    s_mov_b32 s80, 131072
    s_call_b64 s[66:67], L_ldwq
    s_add_u32 s79, s47, 5
    s_and_b32 s79, s79, 7
    s_lshl_b32 s79, s79, 14
    s_add_u32 s79, s79, s42
    s_mov_b32 s80, 65536
    s_call_b64 s[66:67], L_ldk
    s_add_u32 s79, s47, 4
    s_and_b32 s79, s79, 7
    s_lshl_b32 s79, s79, 14
    s_add_u32 s79, s79, s42
    s_mov_b32 s80, 81920
    s_call_b64 s[66:67], L_ldv
    s_waitcnt vmcnt(32)
    s_barrier
    s_add_u32 s68, s78, 6
    s_cmp_ge_u32 s68, 10
    s_cselect_b32 s38, 10, 0
    s_sub_u32 s68, s68, s38
    s_lshl_b32 s79, s68, 7
    s_add_u32 s79, s79, s69
    s_mov_b32 s80, 114688
    s_call_b64 s[66:67], L_ldx
    s_lshl_b32 s79, s68, 19
    s_lshl_b32 s38, s70, 8
    s_add_u32 s79, s79, s38
    s_add_u32 s79, s79, 1024
    s_mov_b32 s80, 98304
    s_call_b64 s[66:67], L_ldwq
    s_add_u32 s79, s47, 6
    s_and_b32 s79, s79, 7
    s_lshl_b32 s79, s79, 14
    s_add_u32 s79, s79, s42
    s_mov_b32 s80, 0
    s_call_b64 s[66:67], L_ldk
    s_add_u32 s79, s47, 5
    s_and_b32 s79, s79, 7
    s_lshl_b32 s79, s79, 14
    s_add_u32 s79, s79, s42
    s_mov_b32 s80, 16384
    s_call_b64 s[66:67], L_ldv
    s_waitcnt vmcnt(63)
    s_mov_b32 s37, 0
L_nonce_chk:
    v_readfirstlane_b32 s71, v46
    s_add_u32 s37, s37, 1
    s_cmp_lg_u32 s71, 0
    s_cbranch_scc1 L_nonce_ok
    s_cmp_ge_u32 s37, 200000
    s_cbranch_scc1 L_nonce_ok
    global_load_dword v46, v38, s[62:63] sc0 sc1
    s_waitcnt vmcnt(0)
    s_branch L_nonce_chk
L_nonce_ok:
    v_mov_b32 v44, s71
    v_mov_b32 v45, 159744
    ds_write_b32 v45, v44
    s_waitcnt lgkmcnt(0)
    s_waitcnt vmcnt(32)
    s_barrier
    s_add_u32 s68, s78, 7
    s_cmp_ge_u32 s68, 10
    s_cselect_b32 s38, 10, 0
    s_sub_u32 s68, s68, s38
    s_lshl_b32 s79, s68, 7
    s_add_u32 s79, s79, s69
    s_mov_b32 s80, 147456
    s_call_b64 s[66:67], L_ldx
    s_lshl_b32 s79, s68, 19
    s_lshl_b32 s38, s70, 8
    s_add_u32 s79, s79, s38
    s_add_u32 s79, s79, 1024
    s_mov_b32 s80, 131072
    s_call_b64 s[66:67], L_ldwq
    s_add_u32 s79, s47, 7
    s_and_b32 s79, s79, 7
    s_lshl_b32 s79, s79, 14
    s_add_u32 s79, s79, s42
    s_mov_b32 s80, 32768
    s_call_b64 s[66:67], L_ldk
    s_add_u32 s79, s47, 6
    s_and_b32 s79, s79, 7
    s_lshl_b32 s79, s79, 14
    s_add_u32 s79, s79, s42
    s_mov_b32 s80, 49152
    s_call_b64 s[66:67], L_ldv
    s_waitcnt vmcnt(32)
    s_barrier
    s_add_u32 s68, s78, 8
    s_cmp_ge_u32 s68, 10
    s_cselect_b32 s38, 10, 0
    s_sub_u32 s68, s68, s38
    s_lshl_b32 s79, s68, 7
    s_add_u32 s79, s79, s69
    s_mov_b32 s80, 114688
    s_call_b64 s[66:67], L_ldx
    s_lshl_b32 s79, s68, 19
    s_lshl_b32 s38, s70, 8
    s_add_u32 s79, s79, s38
    s_add_u32 s79, s79, 1024
    s_mov_b32 s80, 98304
    s_call_b64 s[66:67], L_ldwq
    s_add_u32 s79, s47, 0
    s_and_b32 s79, s79, 7
    s_lshl_b32 s79, s79, 14
    s_add_u32 s79, s79, s43
    s_mov_b32 s80, 65536
    s_call_b64 s[66:67], L_ldk
    s_add_u32 s79, s47, 7
    s_and_b32 s79, s79, 7
    s_lshl_b32 s79, s79, 14
    s_add_u32 s79, s79, s42
    s_mov_b32 s80, 81920
    s_call_b64 s[66:67], L_ldv
    s_waitcnt vmcnt(32)
    s_barrier
    s_add_u32 s68, s78, 9
    s_cmp_ge_u32 s68, 10
    s_cselect_b32 s38, 10, 0
    s_sub_u32 s68, s68, s38
    s_lshl_b32 s79, s68, 7
    s_add_u32 s79, s79, s69
    s_mov_b32 s80, 147456
    s_call_b64 s[66:67], L_ldx
    s_lshl_b32 s79, s68, 19
    s_lshl_b32 s38, s70, 8
    s_add_u32 s79, s79, s38
    s_add_u32 s79, s79, 1024
    s_mov_b32 s80, 131072
    s_call_b64 s[66:67], L_ldwq
    s_add_u32 s79, s47, 1
    s_and_b32 s79, s79, 7
    s_lshl_b32 s79, s79, 14
    s_add_u32 s79, s79, s43
    s_mov_b32 s80, 0
    s_call_b64 s[66:67], L_ldk
    s_add_u32 s79, s47, 0
    s_and_b32 s79, s79, 7
    s_lshl_b32 s79, s79, 14
    s_add_u32 s79, s79, s43
    s_mov_b32 s80, 16384
    s_call_b64 s[66:67], L_ldv
    s_waitcnt vmcnt(32)
    s_barrier
    s_and_b32 s68, s34, 1
    s_xor_b32 s68, s68, 0
    s_lshl_b32 s38, s35, 1
    s_add_u32 s68, s68, s38
    s_and_b32 s68, s68, 7
    s_mul_i32 s79, s68, 81920
    s_add_u32 s79, s79, s45
    s_mov_b32 s80, 98304
    s_call_b64 s[66:67], L_ldwo
    s_barrier
    s_add_u32 s79, s47, 2
    s_and_b32 s79, s79, 7
    s_lshl_b32 s79, s79, 14
    s_add_u32 s79, s79, s43
    s_mov_b32 s80, 32768
    s_call_b64 s[66:67], L_ldk
    s_add_u32 s79, s47, 1
    s_and_b32 s79, s79, 7
    s_lshl_b32 s79, s79, 14
    s_add_u32 s79, s79, s43
    s_mov_b32 s80, 49152
    s_call_b64 s[66:67], L_ldv
    s_and_b32 s68, s34, 1
    s_xor_b32 s68, s68, 1
    s_lshl_b32 s38, s35, 1
    s_add_u32 s68, s68, s38
    s_and_b32 s68, s68, 7
    s_mul_i32 s79, s68, 81920
    s_add_u32 s79, s79, s45
    s_mov_b32 s80, 131072
    s_call_b64 s[66:67], L_ldwo
    s_add_u32 s79, s47, 3
    s_and_b32 s79, s79, 7
    s_lshl_b32 s79, s79, 14
    s_add_u32 s79, s79, s43
    s_mov_b32 s80, 65536
    s_call_b64 s[66:67], L_ldk
    s_add_u32 s79, s47, 2
    s_and_b32 s79, s79, 7
    s_lshl_b32 s79, s79, 14
    s_add_u32 s79, s79, s43
    s_mov_b32 s80, 81920
    s_call_b64 s[66:67], L_ldv
    s_waitcnt vmcnt(63)
    s_barrier
    buffer_load_dword v40, v39, s[24:27], s64 offen sc1
    s_waitcnt vmcnt(0)
    v_cmp_ne_u32 vcc, s71, v40
    s_nop 0
    s_cbranch_vccz L_pc_f1
    s_mov_b32 s79, s64
    s_call_b64 s[66:67], L_poll
L_pc_f1:
    s_add_u32 s37, s35, 1
    s_and_b32 s37, s37, 3
    s_mul_i32 s37, s37, 24576
    s_add_u32 s37, s37, s46
    v_lshlrev_b32 v47, 7, v1
    buffer_load_dword v54, v47, s[24:27], s37 offen
    s_add_u32 s37, s37, 8192
    buffer_load_dword v55, v47, s[24:27], s37 offen
    s_add_u32 s37, s37, 8192
    buffer_load_dword v56, v47, s[24:27], s37 offen
    s_add_u32 s37, s37, 8192
    s_waitcnt vmcnt(36)
    s_barrier
    s_add_u32 s68, s34, 0
    s_cmp_ge_u32 s68, 6
    s_cselect_b32 s38, 6, 0
    s_sub_u32 s68, s68, s38
    s_cmp_ge_u32 s68, 6
    s_cselect_b32 s38, 6, 0
    s_sub_u32 s68, s68, s38
    s_add_u32 s68, s68, 2
    s_lshl_b32 s38, s35, 1
    s_add_u32 s68, s68, s38
    s_and_b32 s68, s68, 7
    s_mul_i32 s79, s68, 81920
    s_add_u32 s79, s79, s45
    s_mov_b32 s80, 98304
    s_call_b64 s[66:67], L_ldwo
    s_add_u32 s68, s34, 0
    s_cmp_ge_u32 s68, 6
    s_cselect_b32 s38, 6, 0
    s_sub_u32 s68, s68, s38
    s_cmp_ge_u32 s68, 6
    s_cselect_b32 s38, 6, 0
    s_sub_u32 s68, s68, s38
    s_add_u32 s68, s68, 2
    s_lshl_b32 s38, s35, 1
    s_add_u32 s68, s68, s38
    s_and_b32 s68, s68, 7
    s_lshr_b32 s38, s68, 1
    s_mul_i32 s79, s38, 24576
    s_and_b32 s38, s68, 1
    s_lshl_b32 s38, s38, 12
    s_add_u32 s79, s79, s38
    s_add_u32 s79, s79, s46
    s_mov_b32 s80, 118784
    s_call_b64 s[66:67], L_ldo
    s_add_u32 s79, s47, 4
    s_and_b32 s79, s79, 7
    s_lshl_b32 s79, s79, 14
    s_add_u32 s79, s79, s43
    s_mov_b32 s80, 0
    s_call_b64 s[66:67], L_ldk
    s_add_u32 s79, s47, 3
    s_and_b32 s79, s79, 7
    s_lshl_b32 s79, s79, 14
    s_add_u32 s79, s79, s43
    s_mov_b32 s80, 16384
    s_call_b64 s[66:67], L_ldv
    s_waitcnt vmcnt(32)
    s_barrier
    s_add_u32 s68, s34, 1
    s_cmp_ge_u32 s68, 6
    s_cselect_b32 s38, 6, 0
    s_sub_u32 s68, s68, s38
    s_cmp_ge_u32 s68, 6
    s_cselect_b32 s38, 6, 0
    s_sub_u32 s68, s68, s38
    s_add_u32 s68, s68, 2
    s_lshl_b32 s38, s35, 1
    s_add_u32 s68, s68, s38
    s_and_b32 s68, s68, 7
    s_mul_i32 s79, s68, 81920
    s_add_u32 s79, s79, s45
    s_mov_b32 s80, 131072
    s_call_b64 s[66:67], L_ldwo
    s_add_u32 s68, s34, 1
    s_cmp_ge_u32 s68, 6
    s_cselect_b32 s38, 6, 0
    s_sub_u32 s68, s68, s38
    s_cmp_ge_u32 s68, 6
    s_cselect_b32 s38, 6, 0
    s_sub_u32 s68, s68, s38
    s_add_u32 s68, s68, 2
    s_lshl_b32 s38, s35, 1
    s_add_u32 s68, s68, s38
    s_and_b32 s68, s68, 7
    s_lshr_b32 s38, s68, 1
    s_mul_i32 s79, s38, 24576
    s_and_b32 s38, s68, 1
    s_lshl_b32 s38, s38, 12
    s_add_u32 s79, s79, s38
    s_add_u32 s79, s79, s46
    s_mov_b32 s80, 151552
    s_call_b64 s[66:67], L_ldo
    s_add_u32 s79, s47, 5
    s_and_b32 s79, s79, 7
    s_lshl_b32 s79, s79, 14
    s_add_u32 s79, s79, s43
    s_mov_b32 s80, 32768
    s_call_b64 s[66:67], L_ldk
    s_add_u32 s79, s47, 4
    s_and_b32 s79, s79, 7
    s_lshl_b32 s79, s79, 14
    s_add_u32 s79, s79, s43
    s_mov_b32 s80, 49152
    s_call_b64 s[66:67], L_ldv
    s_waitcnt vmcnt(32)
    s_barrier
    s_add_u32 s68, s34, 2
    s_cmp_ge_u32 s68, 6
    s_cselect_b32 s38, 6, 0
    s_sub_u32 s68, s68, s38
    s_cmp_ge_u32 s68, 6
    s_cselect_b32 s38, 6, 0
    s_sub_u32 s68, s68, s38
    s_add_u32 s68, s68, 2
    s_lshl_b32 s38, s35, 1
    s_add_u32 s68, s68, s38
    s_and_b32 s68, s68, 7
    s_mul_i32 s79, s68, 81920
    s_add_u32 s79, s79, s45
    s_mov_b32 s80, 98304
    s_call_b64 s[66:67], L_ldwo
    s_add_u32 s68, s34, 2
    s_cmp_ge_u32 s68, 6
    s_cselect_b32 s38, 6, 0
    s_sub_u32 s68, s68, s38
    s_cmp_ge_u32 s68, 6
    s_cselect_b32 s38, 6, 0
    s_sub_u32 s68, s68, s38
    s_add_u32 s68, s68, 2
    s_lshl_b32 s38, s35, 1
    s_add_u32 s68, s68, s38
    s_and_b32 s68, s68, 7
    s_lshr_b32 s38, s68, 1
    s_mul_i32 s79, s38, 24576
    s_and_b32 s38, s68, 1
    s_lshl_b32 s38, s38, 12
    s_add_u32 s79, s79, s38
    s_add_u32 s79, s79, s46
    s_mov_b32 s80, 118784
    s_call_b64 s[66:67], L_ldo
    s_add_u32 s79, s47, 6
    s_and_b32 s79, s79, 7
    s_lshl_b32 s79, s79, 14
    s_add_u32 s79, s79, s43
    s_mov_b32 s80, 65536
    s_call_b64 s[66:67], L_ldk
    s_add_u32 s79, s47, 5
    s_and_b32 s79, s79, 7
    s_lshl_b32 s79, s79, 14
    s_add_u32 s79, s79, s43
    s_mov_b32 s80, 81920
    s_call_b64 s[66:67], L_ldv
    s_waitcnt vmcnt(32)
    s_barrier
    s_add_u32 s68, s34, 3
    s_cmp_ge_u32 s68, 6
    s_cselect_b32 s38, 6, 0
    s_sub_u32 s68, s68, s38
    s_cmp_ge_u32 s68, 6
    s_cselect_b32 s38, 6, 0
    s_sub_u32 s68, s68, s38
    s_add_u32 s68, s68, 2
    s_lshl_b32 s38, s35, 1
    s_add_u32 s68, s68, s38
    s_and_b32 s68, s68, 7
    s_mul_i32 s79, s68, 81920
    s_add_u32 s79, s79, s45
    s_mov_b32 s80, 131072
    s_call_b64 s[66:67], L_ldwo
    s_add_u32 s68, s34, 3
    s_cmp_ge_u32 s68, 6
    s_cselect_b32 s38, 6, 0
    s_sub_u32 s68, s68, s38
    s_cmp_ge_u32 s68, 6
    s_cselect_b32 s38, 6, 0
    s_sub_u32 s68, s68, s38
    s_add_u32 s68, s68, 2
    s_lshl_b32 s38, s35, 1
    s_add_u32 s68, s68, s38
    s_and_b32 s68, s68, 7
    s_lshr_b32 s38, s68, 1
    s_mul_i32 s79, s38, 24576
    s_and_b32 s38, s68, 1
    s_lshl_b32 s38, s38, 12
    s_add_u32 s79, s79, s38
    s_add_u32 s79, s79, s46
    s_mov_b32 s80, 151552
    s_call_b64 s[66:67], L_ldo
    s_add_u32 s79, s47, 7
    s_and_b32 s79, s79, 7
    s_lshl_b32 s79, s79, 14
    s_add_u32 s79, s79, s43
    s_mov_b32 s80, 0
    s_call_b64 s[66:67], L_ldk
    s_add_u32 s79, s47, 6
    s_and_b32 s79, s79, 7
    s_lshl_b32 s79, s79, 14
    s_add_u32 s79, s79, s43
    s_mov_b32 s80, 16384
    s_call_b64 s[66:67], L_ldv
    s_waitcnt vmcnt(32)
    s_barrier
    s_add_u32 s68, s34, 4
    s_cmp_ge_u32 s68, 6
    s_cselect_b32 s38, 6, 0
    s_sub_u32 s68, s68, s38
    s_cmp_ge_u32 s68, 6
    s_cselect_b32 s38, 6, 0
    s_sub_u32 s68, s68, s38
    s_add_u32 s68, s68, 2
    s_lshl_b32 s38, s35, 1
    s_add_u32 s68, s68, s38
    s_and_b32 s68, s68, 7
    s_mul_i32 s79, s68, 81920
    s_add_u32 s79, s79, s45
    s_mov_b32 s80, 98304
    s_call_b64 s[66:67], L_ldwo
    s_add_u32 s68, s34, 4
    s_cmp_ge_u32 s68, 6
    s_cselect_b32 s38, 6, 0
    s_sub_u32 s68, s68, s38
    s_cmp_ge_u32 s68, 6
    s_cselect_b32 s38, 6, 0
    s_sub_u32 s68, s68, s38
    s_add_u32 s68, s68, 2
    s_lshl_b32 s38, s35, 1
    s_add_u32 s68, s68, s38
    s_and_b32 s68, s68, 7
    s_lshr_b32 s38, s68, 1
    s_mul_i32 s79, s38, 24576
    s_and_b32 s38, s68, 1
    s_lshl_b32 s38, s38, 12
    s_add_u32 s79, s79, s38
    s_add_u32 s79, s79, s46
    s_mov_b32 s80, 118784
    s_call_b64 s[66:67], L_ldo
    s_add_u32 s79, s47, 7
    s_and_b32 s79, s79, 7
    s_lshl_b32 s79, s79, 14
    s_add_u32 s79, s79, s43
    s_mov_b32 s80, 49152
    s_call_b64 s[66:67], L_ldv
    s_waitcnt vmcnt(16)
    s_barrier
    s_add_u32 s68, s34, 5
    s_cmp_ge_u32 s68, 6
    s_cselect_b32 s38, 6, 0
    s_sub_u32 s68, s68, s38
    s_cmp_ge_u32 s68, 6
    s_cselect_b32 s38, 6, 0
    s_sub_u32 s68, s68, s38
    s_add_u32 s68, s68, 2
    s_lshl_b32 s38, s35, 1
    s_add_u32 s68, s68, s38
    s_and_b32 s68, s68, 7
    s_mul_i32 s79, s68, 81920
    s_add_u32 s79, s79, s45
    s_mov_b32 s80, 131072
    s_call_b64 s[66:67], L_ldwo
    s_add_u32 s68, s34, 5
    s_cmp_ge_u32 s68, 6
    s_cselect_b32 s38, 6, 0
    s_sub_u32 s68, s68, s38
    s_cmp_ge_u32 s68, 6
    s_cselect_b32 s38, 6, 0
    s_sub_u32 s68, s68, s38
    s_add_u32 s68, s68, 2
    s_lshl_b32 s38, s35, 1
    s_add_u32 s68, s68, s38
    s_and_b32 s68, s68, 7
    s_lshr_b32 s38, s68, 1
    s_mul_i32 s79, s38, 24576
    s_and_b32 s38, s68, 1
    s_lshl_b32 s38, s38, 12
    s_add_u32 s79, s79, s38
    s_add_u32 s79, s79, s46
    s_mov_b32 s80, 151552
    s_call_b64 s[66:67], L_ldo
    s_waitcnt vmcnt(0)
    s_barrier
    s_add_u32 s49, s34, 0
    s_cmp_ge_u32 s49, 2
    s_cselect_b32 s38, 2, 0
    s_sub_u32 s49, s49, s38
    s_cmp_ge_u32 s49, 2
    s_cselect_b32 s38, 2, 0
    s_sub_u32 s49, s49, s38
    s_cmp_ge_u32 s49, 2
    s_cselect_b32 s38, 2, 0
    s_sub_u32 s49, s49, s38
    s_cmp_ge_u32 s49, 2
    s_cselect_b32 s38, 2, 0
    s_sub_u32 s49, s49, s38
    s_lshl_b32 s49, s49, 2
    s_lshr_b32 s49, 16, s49
    s_and_b32 s49, s49, 15
    s_lshl_b32 s68, s35, 1
    s_add_u32 s68, s68, s49
    s_and_b32 s68, s68, 7
    s_mul_i32 s79, s68, 81920
    s_add_u32 s79, s79, s45
    s_add_u32 s79, s79, 655360
    s_mul_i32 s80, s49, 20480
    s_add_u32 s80, s80, 81920
    s_cmp_ge_u32 s80, 163840
    s_cselect_b32 s38, 163840, 0
    s_sub_u32 s80, s80, s38
    s_call_b64 s[66:67], L_ldwo
    s_add_u32 s49, s34, 1
    s_cmp_ge_u32 s49, 2
    s_cselect_b32 s38, 2, 0
    s_sub_u32 s49, s49, s38
    s_cmp_ge_u32 s49, 2
    s_cselect_b32 s38, 2, 0
    s_sub_u32 s49, s49, s38
    s_cmp_ge_u32 s49, 2
    s_cselect_b32 s38, 2, 0
    s_sub_u32 s49, s49, s38
    s_cmp_ge_u32 s49, 2
    s_cselect_b32 s38, 2, 0
    s_sub_u32 s49, s49, s38
    s_lshl_b32 s49, s49, 2
    s_lshr_b32 s49, 16, s49
    s_and_b32 s49, s49, 15
    s_lshl_b32 s68, s35, 1
    s_add_u32 s68, s68, s49
    s_and_b32 s68, s68, 7
    s_mul_i32 s79, s68, 81920
    s_add_u32 s79, s79, s45
    s_add_u32 s79, s79, 655360
    s_mul_i32 s80, s49, 20480
    s_add_u32 s80, s80, 81920
    s_cmp_ge_u32 s80, 163840
    s_cselect_b32 s38, 163840, 0
    s_sub_u32 s80, s80, s38
    s_call_b64 s[66:67], L_ldwo
    s_add_u32 s49, s34, 0
    s_cmp_ge_u32 s49, 1
    s_cselect_b32 s38, 1, 0
    s_sub_u32 s49, s49, s38
    s_cmp_ge_u32 s49, 1
    s_cselect_b32 s38, 1, 0
    s_sub_u32 s49, s49, s38
    s_cmp_ge_u32 s49, 1
    s_cselect_b32 s38, 1, 0
    s_sub_u32 s49, s49, s38
    s_cmp_ge_u32 s49, 1
    s_cselect_b32 s38, 1, 0
    s_sub_u32 s49, s49, s38
    s_cmp_ge_u32 s49, 1
    s_cselect_b32 s38, 1, 0
    s_sub_u32 s49, s49, s38
    s_cmp_ge_u32 s49, 1
    s_cselect_b32 s38, 1, 0
    s_sub_u32 s49, s49, s38
    s_cmp_ge_u32 s49, 1
    s_cselect_b32 s38, 1, 0
    s_sub_u32 s49, s49, s38
    s_lshl_b32 s49, s49, 2
    s_lshr_b32 s49, 4, s49
    s_and_b32 s49, s49, 15
    s_lshl_b32 s68, s35, 1
    s_add_u32 s68, s68, s49
    s_and_b32 s68, s68, 7
    s_mul_i32 s79, s68, 81920
    s_add_u32 s79, s79, s45
    s_add_u32 s79, s79, 655360
    s_mul_i32 s80, s49, 20480
    s_add_u32 s80, s80, 81920
    s_cmp_ge_u32 s80, 163840
    s_cselect_b32 s38, 163840, 0
    s_sub_u32 s80, s80, s38
    s_call_b64 s[66:67], L_ldwo
    s_waitcnt vmcnt(20)
    s_barrier
    s_barrier
    s_add_u32 s49, s34, 0
    s_cmp_ge_u32 s49, 5
    s_cselect_b32 s38, 5, 0
    s_sub_u32 s49, s49, s38
    s_cmp_ge_u32 s49, 5
    s_cselect_b32 s38, 5, 0
    s_sub_u32 s49, s49, s38
    s_lshl_b32 s49, s49, 2
    s_lshr_b32 s49, 484658, s49
    s_and_b32 s49, s49, 15
    s_lshl_b32 s68, s35, 1
    s_add_u32 s68, s68, s49
    s_and_b32 s68, s68, 7
    s_mul_i32 s79, s68, 81920
    s_add_u32 s79, s79, s45
    s_add_u32 s79, s79, 655360
    s_mul_i32 s80, s49, 20480
    s_add_u32 s80, s80, 81920
    s_cmp_ge_u32 s80, 163840
    s_cselect_b32 s38, 163840, 0
    s_sub_u32 s80, s80, s38
    s_call_b64 s[66:67], L_ldwo
    s_add_u32 s49, s34, 1
    s_cmp_ge_u32 s49, 5
    s_cselect_b32 s38, 5, 0
    s_sub_u32 s49, s49, s38
    s_cmp_ge_u32 s49, 5
    s_cselect_b32 s38, 5, 0
    s_sub_u32 s49, s49, s38
    s_lshl_b32 s49, s49, 2
    s_lshr_b32 s49, 484658, s49
    s_and_b32 s49, s49, 15
    s_lshl_b32 s68, s35, 1
    s_add_u32 s68, s68, s49
    s_and_b32 s68, s68, 7
    s_mul_i32 s79, s68, 81920
    s_add_u32 s79, s79, s45
    s_add_u32 s79, s79, 655360
    s_mul_i32 s80, s49, 20480
    s_add_u32 s80, s80, 81920
    s_cmp_ge_u32 s80, 163840
    s_cselect_b32 s38, 163840, 0
    s_sub_u32 s80, s80, s38
    s_call_b64 s[66:67], L_ldwo
    s_add_u32 s49, s34, 2
    s_cmp_ge_u32 s49, 5
    s_cselect_b32 s38, 5, 0
    s_sub_u32 s49, s49, s38
    s_cmp_ge_u32 s49, 5
    s_cselect_b32 s38, 5, 0
    s_sub_u32 s49, s49, s38
    s_lshl_b32 s49, s49, 2
    s_lshr_b32 s49, 484658, s49
    s_and_b32 s49, s49, 15
    s_lshl_b32 s68, s35, 1
    s_add_u32 s68, s68, s49
    s_and_b32 s68, s68, 7
    s_mul_i32 s79, s68, 81920
    s_add_u32 s79, s79, s45
    s_add_u32 s79, s79, 655360
    s_mul_i32 s80, s49, 20480
    s_add_u32 s80, s80, 81920
    s_cmp_ge_u32 s80, 163840
    s_cselect_b32 s38, 163840, 0
    s_sub_u32 s80, s80, s38
    s_call_b64 s[66:67], L_ldwo
    s_add_u32 s49, s34, 3
    s_cmp_ge_u32 s49, 5
    s_cselect_b32 s38, 5, 0
    s_sub_u32 s49, s49, s38
    s_cmp_ge_u32 s49, 5
    s_cselect_b32 s38, 5, 0
    s_sub_u32 s49, s49, s38
    s_lshl_b32 s49, s49, 2
    s_lshr_b32 s49, 484658, s49
    s_and_b32 s49, s49, 15
    s_lshl_b32 s68, s35, 1
    s_add_u32 s68, s68, s49
    s_and_b32 s68, s68, 7
    s_mul_i32 s79, s68, 81920
    s_add_u32 s79, s79, s45
    s_add_u32 s79, s79, 655360
    s_mul_i32 s80, s49, 20480
    s_add_u32 s80, s80, 81920
    s_cmp_ge_u32 s80, 163840
    s_cselect_b32 s38, 163840, 0
    s_sub_u32 s80, s80, s38
    s_call_b64 s[66:67], L_ldwo
    s_add_u32 s49, s34, 4
    s_cmp_ge_u32 s49, 5
    s_cselect_b32 s38, 5, 0
    s_sub_u32 s49, s49, s38
    s_cmp_ge_u32 s49, 5
    s_cselect_b32 s38, 5, 0
    s_sub_u32 s49, s49, s38
    s_lshl_b32 s49, s49, 2
    s_lshr_b32 s49, 484658, s49
    s_and_b32 s49, s49, 15
    s_lshl_b32 s68, s35, 1
    s_add_u32 s68, s68, s49
    s_and_b32 s68, s68, 7
    s_mul_i32 s79, s68, 81920
    s_add_u32 s79, s79, s45
    s_add_u32 s79, s79, 655360
    s_mul_i32 s80, s49, 20480
    s_add_u32 s80, s80, 81920
    s_cmp_ge_u32 s80, 163840
    s_cselect_b32 s38, 163840, 0
    s_sub_u32 s80, s80, s38
    s_call_b64 s[66:67], L_ldwo
    s_waitcnt vmcnt(0)
    s_barrier
    s_endpgm
L_ldk:
    s_add_u32 m0, s80, 0
    s_add_u32 s36, s79, 0
    buffer_load_dwordx4 v16, s[4:7], s36 offen offset:0 nt lds
    buffer_load_dwordx4 v17, s[4:7], s36 offen offset:1024 nt lds
    buffer_load_dwordx4 v18, s[4:7], s36 offen offset:2048 nt lds
    buffer_load_dwordx4 v19, s[4:7], s36 offen offset:3072 nt lds
    s_add_u32 m0, s80, 4096
    s_add_u32 s36, s79, 4096
    buffer_load_dwordx4 v16, s[4:7], s36 offen offset:0 nt lds
    buffer_load_dwordx4 v17, s[4:7], s36 offen offset:1024 nt lds
    buffer_load_dwordx4 v18, s[4:7], s36 offen offset:2048 nt lds
    buffer_load_dwordx4 v19, s[4:7], s36 offen offset:3072 nt lds
    s_add_u32 m0, s80, 8192
    s_add_u32 s36, s79, 8192
    buffer_load_dwordx4 v16, s[4:7], s36 offen offset:0 nt lds
    buffer_load_dwordx4 v17, s[4:7], s36 offen offset:1024 nt lds
    buffer_load_dwordx4 v18, s[4:7], s36 offen offset:2048 nt lds
    buffer_load_dwordx4 v19, s[4:7], s36 offen offset:3072 nt lds
    s_add_u32 m0, s80, 12288
    s_add_u32 s36, s79, 12288
    buffer_load_dwordx4 v16, s[4:7], s36 offen offset:0 nt lds
    buffer_load_dwordx4 v17, s[4:7], s36 offen offset:1024 nt lds
    buffer_load_dwordx4 v18, s[4:7], s36 offen offset:2048 nt lds
    buffer_load_dwordx4 v19, s[4:7], s36 offen offset:3072 nt lds
    s_setpc_b64 s[66:67]
L_ldv:
    s_add_u32 m0, s80, 0
    s_add_u32 s36, s79, 0
    buffer_load_dwordx4 v20, s[8:11], s36 offen offset:0 nt lds
    buffer_load_dwordx4 v20, s[8:11], s36 offen offset:1024 nt lds
    buffer_load_dwordx4 v20, s[8:11], s36 offen offset:2048 nt lds
    buffer_load_dwordx4 v20, s[8:11], s36 offen offset:3072 nt lds
    s_add_u32 m0, s80, 4096
    s_add_u32 s36, s79, 4096
    buffer_load_dwordx4 v20, s[8:11], s36 offen offset:0 nt lds
    buffer_load_dwordx4 v20, s[8:11], s36 offen offset:1024 nt lds
    buffer_load_dwordx4 v20, s[8:11], s36 offen offset:2048 nt lds
    buffer_load_dwordx4 v20, s[8:11], s36 offen offset:3072 nt lds
    s_add_u32 m0, s80, 8192
    s_add_u32 s36, s79, 8192
    buffer_load_dwordx4 v20, s[8:11], s36 offen offset:0 nt lds
    buffer_load_dwordx4 v20, s[8:11], s36 offen offset:1024 nt lds
    buffer_load_dwordx4 v20, s[8:11], s36 offen offset:2048 nt lds
    buffer_load_dwordx4 v20, s[8:11], s36 offen offset:3072 nt lds
    s_add_u32 m0, s80, 12288
    s_add_u32 s36, s79, 12288
    buffer_load_dwordx4 v20, s[8:11], s36 offen offset:0 nt lds
    buffer_load_dwordx4 v20, s[8:11], s36 offen offset:1024 nt lds
    buffer_load_dwordx4 v20, s[8:11], s36 offen offset:2048 nt lds
    buffer_load_dwordx4 v20, s[8:11], s36 offen offset:3072 nt lds
    s_setpc_b64 s[66:67]
L_ldwq:
    s_add_u32 m0, s80, 0
    s_add_u32 s36, s79, 0
    buffer_load_dwordx4 v24, s[12:15], s36 offen offset:0 lds
    buffer_load_dwordx4 v25, s[12:15], s36 offen offset:1024 lds
    buffer_load_dwordx4 v26, s[12:15], s36 offen offset:2048 lds
    buffer_load_dwordx4 v27, s[12:15], s36 offen offset:3072 lds
    s_add_u32 m0, s80, 4096
    s_add_u32 s36, s79, 131072
    buffer_load_dwordx4 v24, s[12:15], s36 offen offset:0 lds
    buffer_load_dwordx4 v25, s[12:15], s36 offen offset:1024 lds
    buffer_load_dwordx4 v26, s[12:15], s36 offen offset:2048 lds
    buffer_load_dwordx4 v27, s[12:15], s36 offen offset:3072 lds
    s_add_u32 m0, s80, 8192
    s_add_u32 s36, s79, 262144
    buffer_load_dwordx4 v24, s[12:15], s36 offen offset:0 lds
    buffer_load_dwordx4 v25, s[12:15], s36 offen offset:1024 lds
    buffer_load_dwordx4 v26, s[12:15], s36 offen offset:2048 lds
    buffer_load_dwordx4 v27, s[12:15], s36 offen offset:3072 lds
    s_add_u32 m0, s80, 12288
    s_add_u32 s36, s79, 393216
    buffer_load_dwordx4 v24, s[12:15], s36 offen offset:0 lds
    buffer_load_dwordx4 v25, s[12:15], s36 offen offset:1024 lds
    buffer_load_dwordx4 v26, s[12:15], s36 offen offset:2048 lds
    buffer_load_dwordx4 v27, s[12:15], s36 offen offset:3072 lds
    s_setpc_b64 s[66:67]
L_ldx:
    s_add_u32 m0, s80, 0
    s_add_u32 s36, s79, 0
    buffer_load_dwordx4 v28, s[16:19], s36 offen offset:0 lds
    buffer_load_dwordx4 v29, s[16:19], s36 offen offset:1024 lds
    buffer_load_dwordx4 v30, s[16:19], s36 offen offset:2048 lds
    buffer_load_dwordx4 v31, s[16:19], s36 offen offset:3072 lds
    s_add_u32 m0, s80, 4096
    s_add_u32 s36, s79, 40960
    buffer_load_dwordx4 v28, s[16:19], s36 offen offset:0 lds
    buffer_load_dwordx4 v29, s[16:19], s36 offen offset:1024 lds
    buffer_load_dwordx4 v30, s[16:19], s36 offen offset:2048 lds
    buffer_load_dwordx4 v31, s[16:19], s36 offen offset:3072 lds
    s_add_u32 m0, s80, 8192
    s_add_u32 s36, s79, 81920
    buffer_load_dwordx4 v28, s[16:19], s36 offen offset:0 lds
    buffer_load_dwordx4 v29, s[16:19], s36 offen offset:1024 lds
    buffer_load_dwordx4 v30, s[16:19], s36 offen offset:2048 lds
    buffer_load_dwordx4 v31, s[16:19], s36 offen offset:3072 lds
    s_setpc_b64 s[66:67]
L_ldwo:
    s_add_u32 m0, s80, 0
    s_add_u32 s36, s79, 0
    buffer_load_dwordx4 v32, s[20:23], s36 offen offset:0 lds
    buffer_load_dwordx4 v33, s[20:23], s36 offen offset:1024 lds
    buffer_load_dwordx4 v34, s[20:23], s36 offen offset:2048 lds
    buffer_load_dwordx4 v35, s[20:23], s36 offen offset:3072 lds
    s_add_u32 m0, s80, 4096
    s_nop 0
    buffer_load_dwordx4 v36, s[20:23], s36 offen lds
    s_add_u32 m0, s80, 5120
    s_add_u32 s36, s79, 20480
    buffer_load_dwordx4 v32, s[20:23], s36 offen offset:0 lds
    buffer_load_dwordx4 v33, s[20:23], s36 offen offset:1024 lds
    buffer_load_dwordx4 v34, s[20:23], s36 offen offset:2048 lds
    buffer_load_dwordx4 v35, s[20:23], s36 offen offset:3072 lds
    s_add_u32 m0, s80, 9216
    s_nop 0
    buffer_load_dwordx4 v36, s[20:23], s36 offen lds
    s_add_u32 m0, s80, 10240
    s_add_u32 s36, s79, 40960
    buffer_load_dwordx4 v32, s[20:23], s36 offen offset:0 lds
    buffer_load_dwordx4 v33, s[20:23], s36 offen offset:1024 lds
    buffer_load_dwordx4 v34, s[20:23], s36 offen offset:2048 lds
    buffer_load_dwordx4 v35, s[20:23], s36 offen offset:3072 lds
    s_add_u32 m0, s80, 14336
    s_nop 0
    buffer_load_dwordx4 v36, s[20:23], s36 offen lds
    s_add_u32 m0, s80, 15360
    s_add_u32 s36, s79, 61440
    buffer_load_dwordx4 v32, s[20:23], s36 offen offset:0 lds
    buffer_load_dwordx4 v33, s[20:23], s36 offen offset:1024 lds
    buffer_load_dwordx4 v34, s[20:23], s36 offen offset:2048 lds
    buffer_load_dwordx4 v35, s[20:23], s36 offen offset:3072 lds
    s_add_u32 m0, s80, 19456
    s_nop 0
    buffer_load_dwordx4 v36, s[20:23], s36 offen lds
    s_setpc_b64 s[66:67]
L_ldwo2:
    s_add_u32 m0, s80, 0
    s_add_u32 s36, s79, 0
    buffer_load_dwordx4 v32, s[20:23], s36 offen offset:0 nt lds
    buffer_load_dwordx4 v33, s[20:23], s36 offen offset:1024 nt lds
    buffer_load_dwordx4 v34, s[20:23], s36 offen offset:2048 nt lds
    buffer_load_dwordx4 v35, s[20:23], s36 offen offset:3072 nt lds
    s_add_u32 m0, s80, 4096
    s_nop 0
    buffer_load_dwordx4 v36, s[20:23], s36 offen nt lds
    s_add_u32 m0, s80, 5120
    s_add_u32 s36, s79, 20480
    buffer_load_dwordx4 v32, s[20:23], s36 offen offset:0 nt lds
    buffer_load_dwordx4 v33, s[20:23], s36 offen offset:1024 nt lds
    buffer_load_dwordx4 v34, s[20:23], s36 offen offset:2048 nt lds
    buffer_load_dwordx4 v35, s[20:23], s36 offen offset:3072 nt lds
    s_add_u32 m0, s80, 9216
    s_nop 0
    buffer_load_dwordx4 v36, s[20:23], s36 offen nt lds
    s_add_u32 m0, s80, 10240
    s_add_u32 s36, s79, 40960
    buffer_load_dwordx4 v32, s[20:23], s36 offen offset:0 nt lds
    buffer_load_dwordx4 v33, s[20:23], s36 offen offset:1024 nt lds
    buffer_load_dwordx4 v34, s[20:23], s36 offen offset:2048 nt lds
    buffer_load_dwordx4 v35, s[20:23], s36 offen offset:3072 nt lds
    s_add_u32 m0, s80, 14336
    s_nop 0
    buffer_load_dwordx4 v36, s[20:23], s36 offen nt lds
    s_add_u32 m0, s80, 15360
    s_add_u32 s36, s79, 61440
    buffer_load_dwordx4 v32, s[20:23], s36 offen offset:0 nt lds
    buffer_load_dwordx4 v33, s[20:23], s36 offen offset:1024 nt lds
    buffer_load_dwordx4 v34, s[20:23], s36 offen offset:2048 nt lds
    buffer_load_dwordx4 v35, s[20:23], s36 offen offset:3072 nt lds
    s_add_u32 m0, s80, 19456
    s_nop 0
    buffer_load_dwordx4 v36, s[20:23], s36 offen nt lds
    s_setpc_b64 s[66:67]
L_ldo:
    s_add_u32 m0, s80, 0
    s_add_u32 s36, s79, 0
    buffer_load_dwordx4 v37, s[24:27], s36 offen offset:0 lds
    buffer_load_dwordx4 v37, s[24:27], s36 offen offset:1024 lds
    buffer_load_dwordx4 v37, s[24:27], s36 offen offset:2048 lds
    buffer_load_dwordx4 v37, s[24:27], s36 offen offset:3072 lds
    s_add_u32 m0, s80, 4096
    s_add_u32 s36, s79, 8192
    buffer_load_dwordx4 v37, s[24:27], s36 offen offset:0 lds
    buffer_load_dwordx4 v37, s[24:27], s36 offen offset:1024 lds
    buffer_load_dwordx4 v37, s[24:27], s36 offen offset:2048 lds
    buffer_load_dwordx4 v37, s[24:27], s36 offen offset:3072 lds
    s_add_u32 m0, s80, 8192
    s_add_u32 s36, s79, 16384
    buffer_load_dwordx4 v37, s[24:27], s36 offen offset:0 lds
    buffer_load_dwordx4 v37, s[24:27], s36 offen offset:1024 lds
    buffer_load_dwordx4 v37, s[24:27], s36 offen offset:2048 lds
    buffer_load_dwordx4 v37, s[24:27], s36 offen offset:3072 lds
    s_setpc_b64 s[66:67]
L_poll:
    s_mov_b32 s37, 0
L_poll_loop:
    buffer_load_dword v40, v39, s[24:27], s79 offen sc1
    s_waitcnt vmcnt(0)
    v_cmp_ne_u32 vcc, s71, v40
    s_add_u32 s37, s37, 1
    s_cbranch_vccz L_poll_done
    s_cmp_ge_u32 s37, 200000
    s_cbranch_scc1 L_poll_done
    s_sleep 1
    s_branch L_poll_loop
L_poll_done:
    s_setpc_b64 s[66:67]
L_compute:
    v_lshrrev_b32 v2, 5, v1
    v_and_b32 v3, 31, v1
    v_and_b32 v4, 15, v1
    v_xor_b32 v4, v4, v2
    v_lshlrev_b32 v5, 8, v3
    v_xor_b32 v6, 0, v4
    v_lshl_add_u32 v16, v6, 4, v5
    v_xor_b32 v6, 2, v4
    v_lshl_add_u32 v17, v6, 4, v5
    v_xor_b32 v6, 4, v4
    v_lshl_add_u32 v18, v6, 4, v5
    v_xor_b32 v6, 6, v4
    v_lshl_add_u32 v19, v6, 4, v5
    v_xor_b32 v6, 8, v4
    v_lshl_add_u32 v20, v6, 4, v5
    v_xor_b32 v6, 10, v4
    v_lshl_add_u32 v21, v6, 4, v5
    v_xor_b32 v6, 12, v4
    v_lshl_add_u32 v22, v6, 4, v5
    v_xor_b32 v6, 14, v4
    v_lshl_add_u32 v23, v6, 4, v5
    v_lshrrev_b32 v6, 2, v1
    v_and_b32 v6, 3, v6
    v_and_b32 v7, 3, v1
    v_and_b32 v8, 1, v7
    v_lshlrev_b32 v8, 1, v8
    v_lshrrev_b32 v9, 1, v7
    v_or_b32 v8, v8, v9
    v_lshlrev_b32 v8, 3, v8
    v_lshrrev_b32 v9, 4, v1
    v_and_b32 v9, 1, v9
    v_lshl_add_u32 v8, v9, 5, v8
    v_lshl_add_u32 v10, v2, 2, v6
    v_lshlrev_b32 v10, 8, v10
    v_add_u32 v10, v10, v8
    v_lshl_add_u32 v11, v2, 3, v6
    s_movk_i32 s36, 320
    v_mul_lo_u32 v40, v11, s36
    v_add_u32 v40, v40, v8
    v_lshlrev_b32 v11, 8, v11
    v_add_u32 v11, v11, v8
    v_xor_b32 v12, 0, v6
    v_lshlrev_b32 v12, 6, v12
    v_add_u32 v24, v10, v12
    v_add_u32 v28, v11, v12
    v_add_u32 v24, 16384, v24
    v_add_u32 v28, 65536, v28
    v_xor_b32 v12, 1, v6
    v_lshlrev_b32 v12, 6, v12
    v_add_u32 v25, v10, v12
    v_add_u32 v29, v11, v12
    v_add_u32 v25, 16384, v25
    v_add_u32 v29, 65536, v29
    v_xor_b32 v12, 2, v6
    v_lshlrev_b32 v12, 6, v12
    v_add_u32 v26, v10, v12
    v_add_u32 v30, v11, v12
    v_add_u32 v26, 16384, v26
    v_add_u32 v30, 65536, v30
    v_xor_b32 v12, 3, v6
    v_lshlrev_b32 v12, 6, v12
    v_add_u32 v27, v10, v12
    v_add_u32 v31, v11, v12
    v_add_u32 v27, 16384, v27
    v_add_u32 v31, 65536, v31
    s_lshl_b32 s36, s3, 5
    v_add_u32 v12, s36, v3
    v_lshrrev_b32 v13, 1, v12
    v_and_b32 v13, 7, v13
    v_xor_b32 v13, v13, v2
    v_lshlrev_b32 v14, 7, v12
    v_xor_b32 v15, 0, v13
    v_lshl_add_u32 v32, v15, 4, v14
    v_add_u32 v32, 81920, v32
    v_xor_b32 v15, 2, v13
    v_lshl_add_u32 v33, v15, 4, v14
    v_add_u32 v33, 81920, v33
    v_xor_b32 v15, 4, v13
    v_lshl_add_u32 v34, v15, 4, v14
    v_add_u32 v34, 81920, v34
    v_xor_b32 v15, 6, v13
    v_lshl_add_u32 v35, v15, 4, v14
    v_add_u32 v35, 81920, v35
    s_lshl_b32 s36, s3, 12
    s_add_u32 s36, s36, 20480
    v_lshlrev_b32 v42, 4, v1
    v_add_u32 v41, s36, v42
    v_mov_b32 v43, 0
    s_waitcnt lgkmcnt(0)
    s_cmp_eq_u32 s32, 0
    s_cselect_b32 s16, s40, s50
    s_cselect_b32 s17, s41, s51
    s_cselect_b32 s12, s46, s56
    s_cselect_b32 s13, s47, s57
    s_cselect_b32 s4, s42, s52
    s_cselect_b32 s5, s43, s53
    s_cselect_b32 s8, s44, s54
    s_cselect_b32 s9, s45, s55
    s_cselect_b32 s20, s48, s58
    s_cselect_b32 s21, s49, s59
    s_mov_b32 s18, 983040
    s_mov_b32 s19, 0x20000
    s_and_b32 s17, s17, 0xffff
    s_mov_b32 s14, 5242880
    s_mov_b32 s15, 0x20000
    s_and_b32 s13, s13, 0xffff
    s_mov_b32 s6, 33554432
    s_mov_b32 s7, 0x20000
    s_and_b32 s5, s5, 0xffff
    s_mov_b32 s10, 33554432
    s_mov_b32 s11, 0x20000
    s_and_b32 s9, s9, 0xffff
    s_mov_b32 s22, 5242880
    s_mov_b32 s23, 0x20000
    s_and_b32 s21, s21, 0xffff
    s_mov_b32 s28, s60
    s_and_b32 s29, s61, 0xffff
    s_mov_b32 s30, 1966080
    s_mov_b32 s31, 0x20000
    s_mov_b32 s24, s64
    s_and_b32 s25, s65, 0xffff
    s_mov_b32 s26, 268435456
    s_mov_b32 s27, 0x20000
    s_lshl_b32 s64, s32, 2
    s_add_u32 s64, s64, s33
    s_lshl_b32 s64, s64, 3
    s_add_u32 s64, s64, s34
    s_lshl_b32 s64, s64, 7
    s_add_u32 s64, s64, 41943040
    s_lshl_b32 s65, s32, 3
    s_add_u32 s65, s65, s34
    s_lshl_b32 s65, s65, 2
    s_add_u32 s65, s65, s35
    s_lshl_b32 s65, s65, 7
    s_add_u32 s65, s65, 41975808
    s_mov_b32 s76, 0x47800000
    s_mov_b32 s60, 0x3e0293ee
    s_mov_b32 s61, 0x3e0293ee
    s_mov_b32 s72, 0
    s_lshl_b32 s70, s33, 3
    s_add_u32 s70, s70, s35
    v_pk_mov_b32 v[208:209], 0, 0
    v_pk_mov_b32 v[210:211], 0, 0
    v_pk_mov_b32 v[212:213], 0, 0
    v_pk_mov_b32 v[214:215], 0, 0
    v_pk_mov_b32 v[216:217], 0, 0
    v_pk_mov_b32 v[218:219], 0, 0
    v_pk_mov_b32 v[220:221], 0, 0
    v_pk_mov_b32 v[222:223], 0, 0
    v_pk_mov_b32 v[224:225], 0, 0
    v_pk_mov_b32 v[226:227], 0, 0
    v_pk_mov_b32 v[228:229], 0, 0
    v_pk_mov_b32 v[230:231], 0, 0
    v_pk_mov_b32 v[232:233], 0, 0
    v_pk_mov_b32 v[234:235], 0, 0
    v_pk_mov_b32 v[236:237], 0, 0
    v_pk_mov_b32 v[238:239], 0, 0
    s_barrier
    ds_read_b128 v[176:179], v32 offset:0
    ds_read_b128 v[180:183], v33 offset:0
    ds_read_b128 v[184:187], v34 offset:0
    ds_read_b128 v[188:191], v35 offset:0
    ds_read_b64_tr_b16 a[64:65], v28 offset:0
    ds_read_b64_tr_b16 a[66:67], v28 offset:1024
    ds_read_b64_tr_b16 a[68:69], v29 offset:0
    ds_read_b64_tr_b16 a[70:71], v29 offset:1024
    ds_read_b64_tr_b16 a[72:73], v30 offset:0
    ds_read_b64_tr_b16 a[74:75], v30 offset:1024
    ds_read_b64_tr_b16 a[76:77], v31 offset:0
    ds_read_b64_tr_b16 a[78:79], v31 offset:1024
    ds_read_b64_tr_b16 a[80:81], v28 offset:4096
    ds_read_b64_tr_b16 a[82:83], v28 offset:5120
    ds_read_b64_tr_b16 a[84:85], v29 offset:4096
    ds_read_b64_tr_b16 a[86:87], v29 offset:5120
    ds_read_b64_tr_b16 a[88:89], v30 offset:4096
    ds_read_b64_tr_b16 a[90:91], v30 offset:5120
    ds_read_b64_tr_b16 a[92:93], v31 offset:4096
    ds_read_b64_tr_b16 a[94:95], v31 offset:5120
    ds_read_b64_tr_b16 a[96:97], v28 offset:8192
    ds_read_b64_tr_b16 a[98:99], v28 offset:9216
    ds_read_b64_tr_b16 a[100:101], v29 offset:8192
    ds_read_b64_tr_b16 a[102:103], v29 offset:9216
    ds_read_b64_tr_b16 a[104:105], v30 offset:8192
    ds_read_b64_tr_b16 a[106:107], v30 offset:9216
    ds_read_b64_tr_b16 a[108:109], v31 offset:8192
    ds_read_b64_tr_b16 a[110:111], v31 offset:9216
    ds_read_b64_tr_b16 a[112:113], v28 offset:12288
    ds_read_b64_tr_b16 a[114:115], v28 offset:13312
    ds_read_b64_tr_b16 a[116:117], v29 offset:12288
    ds_read_b64_tr_b16 a[118:119], v29 offset:13312
    ds_read_b64_tr_b16 a[120:121], v30 offset:12288
    ds_read_b64_tr_b16 a[122:123], v30 offset:13312
    ds_read_b64_tr_b16 a[124:125], v31 offset:12288
    ds_read_b64_tr_b16 a[126:127], v31 offset:13312
    v_add_u32 v28, 0x8000, v28
    v_add_u32 v29, 0x8000, v29
    v_add_u32 v30, 0x8000, v30
    v_add_u32 v31, 0x8000, v31
    v_add_u32 v32, 0x8000, v32
    v_add_u32 v33, 0x8000, v33
    v_add_u32 v34, 0x8000, v34
    v_add_u32 v35, 0x8000, v35
    s_waitcnt lgkmcnt(0)
    s_barrier
    v_mfma_f32_32x32x16_bf16 v[48:63], a[64:67], v[176:179], 0
    ds_read_b128 v[192:195], v32 offset:0
    ds_read_b128 v[196:199], v33 offset:0
    ds_read_b128 v[200:203], v34 offset:0
    v_mfma_f32_32x32x16_bf16 v[64:79], a[68:71], v[176:179], 0
    ds_read_b128 v[204:207], v35 offset:0
    ds_read_b64_tr_b16 a[128:129], v28 offset:0
    ds_read_b64_tr_b16 a[130:131], v28 offset:1024
    v_mfma_f32_32x32x16_bf16 v[80:95], a[72:75], v[176:179], 0
    ds_read_b64_tr_b16 a[132:133], v29 offset:0
    ds_read_b64_tr_b16 a[134:135], v29 offset:1024
    ds_read_b64_tr_b16 a[136:137], v30 offset:0
    v_mfma_f32_32x32x16_bf16 v[96:111], a[76:79], v[176:179], 0
    ds_read_b64_tr_b16 a[138:139], v30 offset:1024
    ds_read_b64_tr_b16 a[140:141], v31 offset:0
    ds_read_b64_tr_b16 a[142:143], v31 offset:1024
    v_mfma_f32_32x32x16_bf16 v[48:63], a[80:83], v[180:183], v[48:63]
    ds_read_b64_tr_b16 a[144:145], v28 offset:4096
    ds_read_b64_tr_b16 a[146:147], v28 offset:5120
    ds_read_b64_tr_b16 a[148:149], v29 offset:4096
    v_mfma_f32_32x32x16_bf16 v[64:79], a[84:87], v[180:183], v[64:79]
    ds_read_b64_tr_b16 a[150:151], v29 offset:5120
    ds_read_b64_tr_b16 a[152:153], v30 offset:4096
    ds_read_b64_tr_b16 a[154:155], v30 offset:5120
    v_mfma_f32_32x32x16_bf16 v[80:95], a[88:91], v[180:183], v[80:95]
    ds_read_b64_tr_b16 a[156:157], v31 offset:4096
    ds_read_b64_tr_b16 a[158:159], v31 offset:5120
    ds_read_b64_tr_b16 a[160:161], v28 offset:8192
    v_mfma_f32_32x32x16_bf16 v[96:111], a[92:95], v[180:183], v[96:111]
    ds_read_b64_tr_b16 a[162:163], v28 offset:9216
    ds_read_b64_tr_b16 a[164:165], v29 offset:8192
    ds_read_b64_tr_b16 a[166:167], v29 offset:9216
    v_mfma_f32_32x32x16_bf16 v[48:63], a[96:99], v[184:187], v[48:63]
    ds_read_b64_tr_b16 a[168:169], v30 offset:8192
    ds_read_b64_tr_b16 a[170:171], v30 offset:9216
    ds_read_b64_tr_b16 a[172:173], v31 offset:8192
    v_mfma_f32_32x32x16_bf16 v[64:79], a[100:103], v[184:187], v[64:79]
    ds_read_b64_tr_b16 a[174:175], v31 offset:9216
    ds_read_b64_tr_b16 a[176:177], v28 offset:12288
    ds_read_b64_tr_b16 a[178:179], v28 offset:13312
    v_mfma_f32_32x32x16_bf16 v[80:95], a[104:107], v[184:187], v[80:95]
    ds_read_b64_tr_b16 a[180:181], v29 offset:12288
    ds_read_b64_tr_b16 a[182:183], v29 offset:13312
    ds_read_b64_tr_b16 a[184:185], v30 offset:12288
    v_mfma_f32_32x32x16_bf16 v[96:111], a[108:111], v[184:187], v[96:111]
    ds_read_b64_tr_b16 a[186:187], v30 offset:13312
    ds_read_b64_tr_b16 a[188:189], v31 offset:12288
    ds_read_b64_tr_b16 a[190:191], v31 offset:13312
    v_mfma_f32_32x32x16_bf16 v[48:63], a[112:115], v[188:191], v[48:63]
    v_add_u32 v28, 0x8000, v28
    v_add_u32 v29, 0x8000, v29
    v_add_u32 v30, 0x8000, v30
    v_mfma_f32_32x32x16_bf16 v[64:79], a[116:119], v[188:191], v[64:79]
    v_add_u32 v31, 0x8000, v31
    v_add_u32 v32, 0x8000, v32
    v_add_u32 v33, 0x8000, v33
    v_mfma_f32_32x32x16_bf16 v[80:95], a[120:123], v[188:191], v[80:95]
    v_add_u32 v34, 0x8000, v34
    v_add_u32 v35, 0x8000, v35
    v_mfma_f32_32x32x16_bf16 v[96:111], a[124:127], v[188:191], v[96:111]
    s_waitcnt lgkmcnt(0)
    s_mov_b32 s73, 2
    s_mov_b32 s81, 2
L_q_loop:
    s_barrier
    s_mov_b32 s36, 32768
    s_cmp_eq_u32 s81, 2
    s_cselect_b32 s74, 4294901760, s36
    s_add_u32 s81, s81, 1
    s_cmp_eq_u32 s81, 3
    s_cselect_b32 s81, 0, s81
    v_mfma_f32_32x32x16_bf16 v[48:63], a[128:131], v[192:195], v[48:63]
    ds_read_b128 v[176:179], v32 offset:0
    ds_read_b128 v[180:183], v33 offset:0
    ds_read_b128 v[184:187], v34 offset:0
    v_mfma_f32_32x32x16_bf16 v[64:79], a[132:135], v[192:195], v[64:79]
    ds_read_b128 v[188:191], v35 offset:0
    ds_read_b64_tr_b16 a[64:65], v28 offset:0
    ds_read_b64_tr_b16 a[66:67], v28 offset:1024
    v_mfma_f32_32x32x16_bf16 v[80:95], a[136:139], v[192:195], v[80:95]
    ds_read_b64_tr_b16 a[68:69], v29 offset:0
    ds_read_b64_tr_b16 a[70:71], v29 offset:1024
    ds_read_b64_tr_b16 a[72:73], v30 offset:0
    v_mfma_f32_32x32x16_bf16 v[96:111], a[140:143], v[192:195], v[96:111]
    ds_read_b64_tr_b16 a[74:75], v30 offset:1024
    ds_read_b64_tr_b16 a[76:77], v31 offset:0
    ds_read_b64_tr_b16 a[78:79], v31 offset:1024
    v_mfma_f32_32x32x16_bf16 v[48:63], a[144:147], v[196:199], v[48:63]
    ds_read_b64_tr_b16 a[80:81], v28 offset:4096
    ds_read_b64_tr_b16 a[82:83], v28 offset:5120
    ds_read_b64_tr_b16 a[84:85], v29 offset:4096
    v_mfma_f32_32x32x16_bf16 v[64:79], a[148:151], v[196:199], v[64:79]
    ds_read_b64_tr_b16 a[86:87], v29 offset:5120
    ds_read_b64_tr_b16 a[88:89], v30 offset:4096
    ds_read_b64_tr_b16 a[90:91], v30 offset:5120
    v_mfma_f32_32x32x16_bf16 v[80:95], a[152:155], v[196:199], v[80:95]
    ds_read_b64_tr_b16 a[92:93], v31 offset:4096
    ds_read_b64_tr_b16 a[94:95], v31 offset:5120
    ds_read_b64_tr_b16 a[96:97], v28 offset:8192
    v_mfma_f32_32x32x16_bf16 v[96:111], a[156:159], v[196:199], v[96:111]
    ds_read_b64_tr_b16 a[98:99], v28 offset:9216
    ds_read_b64_tr_b16 a[100:101], v29 offset:8192
    ds_read_b64_tr_b16 a[102:103], v29 offset:9216
    v_mfma_f32_32x32x16_bf16 v[48:63], a[160:163], v[200:203], v[48:63]
    ds_read_b64_tr_b16 a[104:105], v30 offset:8192
    ds_read_b64_tr_b16 a[106:107], v30 offset:9216
    ds_read_b64_tr_b16 a[108:109], v31 offset:8192
    v_mfma_f32_32x32x16_bf16 v[64:79], a[164:167], v[200:203], v[64:79]
    ds_read_b64_tr_b16 a[110:111], v31 offset:9216
    ds_read_b64_tr_b16 a[112:113], v28 offset:12288
    ds_read_b64_tr_b16 a[114:115], v28 offset:13312
    v_mfma_f32_32x32x16_bf16 v[80:95], a[168:171], v[200:203], v[80:95]
    ds_read_b64_tr_b16 a[116:117], v29 offset:12288
    ds_read_b64_tr_b16 a[118:119], v29 offset:13312
    ds_read_b64_tr_b16 a[120:121], v30 offset:12288
    v_mfma_f32_32x32x16_bf16 v[96:111], a[172:175], v[200:203], v[96:111]
    ds_read_b64_tr_b16 a[122:123], v30 offset:13312
    ds_read_b64_tr_b16 a[124:125], v31 offset:12288
    ds_read_b64_tr_b16 a[126:127], v31 offset:13312
    v_mfma_f32_32x32x16_bf16 v[48:63], a[176:179], v[204:207], v[48:63]
    v_add_u32 v28, s74, v28
    v_add_u32 v29, s74, v29
    v_add_u32 v30, s74, v30
    v_mfma_f32_32x32x16_bf16 v[64:79], a[180:183], v[204:207], v[64:79]
    v_add_u32 v31, s74, v31
    v_add_u32 v32, s74, v32
    v_add_u32 v33, s74, v33
    v_mfma_f32_32x32x16_bf16 v[80:95], a[184:187], v[204:207], v[80:95]
    v_add_u32 v34, s74, v34
    v_add_u32 v35, s74, v35
    v_mfma_f32_32x32x16_bf16 v[96:111], a[188:191], v[204:207], v[96:111]
    s_waitcnt lgkmcnt(0)
    s_barrier
    s_mov_b32 s36, 32768
    s_cmp_eq_u32 s81, 2
    s_cselect_b32 s74, 4294901760, s36
    s_add_u32 s81, s81, 1
    s_cmp_eq_u32 s81, 3
    s_cselect_b32 s81, 0, s81
    v_mfma_f32_32x32x16_bf16 v[48:63], a[64:67], v[176:179], v[48:63]
    ds_read_b128 v[192:195], v32 offset:0
    ds_read_b128 v[196:199], v33 offset:0
    ds_read_b128 v[200:203], v34 offset:0
    v_mfma_f32_32x32x16_bf16 v[64:79], a[68:71], v[176:179], v[64:79]
    ds_read_b128 v[204:207], v35 offset:0
    ds_read_b64_tr_b16 a[128:129], v28 offset:0
    ds_read_b64_tr_b16 a[130:131], v28 offset:1024
    v_mfma_f32_32x32x16_bf16 v[80:95], a[72:75], v[176:179], v[80:95]
    ds_read_b64_tr_b16 a[132:133], v29 offset:0
    ds_read_b64_tr_b16 a[134:135], v29 offset:1024
    ds_read_b64_tr_b16 a[136:137], v30 offset:0
    v_mfma_f32_32x32x16_bf16 v[96:111], a[76:79], v[176:179], v[96:111]
    ds_read_b64_tr_b16 a[138:139], v30 offset:1024
    ds_read_b64_tr_b16 a[140:141], v31 offset:0
    ds_read_b64_tr_b16 a[142:143], v31 offset:1024
    v_mfma_f32_32x32x16_bf16 v[48:63], a[80:83], v[180:183], v[48:63]
    ds_read_b64_tr_b16 a[144:145], v28 offset:4096
    ds_read_b64_tr_b16 a[146:147], v28 offset:5120
    ds_read_b64_tr_b16 a[148:149], v29 offset:4096
    v_mfma_f32_32x32x16_bf16 v[64:79], a[84:87], v[180:183], v[64:79]
    ds_read_b64_tr_b16 a[150:151], v29 offset:5120
    ds_read_b64_tr_b16 a[152:153], v30 offset:4096
    ds_read_b64_tr_b16 a[154:155], v30 offset:5120
    v_mfma_f32_32x32x16_bf16 v[80:95], a[88:91], v[180:183], v[80:95]
    ds_read_b64_tr_b16 a[156:157], v31 offset:4096
    ds_read_b64_tr_b16 a[158:159], v31 offset:5120
    ds_read_b64_tr_b16 a[160:161], v28 offset:8192
    v_mfma_f32_32x32x16_bf16 v[96:111], a[92:95], v[180:183], v[96:111]
    ds_read_b64_tr_b16 a[162:163], v28 offset:9216
    ds_read_b64_tr_b16 a[164:165], v29 offset:8192
    ds_read_b64_tr_b16 a[166:167], v29 offset:9216
    v_mfma_f32_32x32x16_bf16 v[48:63], a[96:99], v[184:187], v[48:63]
    ds_read_b64_tr_b16 a[168:169], v30 offset:8192
    ds_read_b64_tr_b16 a[170:171], v30 offset:9216
    ds_read_b64_tr_b16 a[172:173], v31 offset:8192
    v_mfma_f32_32x32x16_bf16 v[64:79], a[100:103], v[184:187], v[64:79]
    ds_read_b64_tr_b16 a[174:175], v31 offset:9216
    ds_read_b64_tr_b16 a[176:177], v28 offset:12288
    ds_read_b64_tr_b16 a[178:179], v28 offset:13312
    v_mfma_f32_32x32x16_bf16 v[80:95], a[104:107], v[184:187], v[80:95]
    ds_read_b64_tr_b16 a[180:181], v29 offset:12288
    ds_read_b64_tr_b16 a[182:183], v29 offset:13312
    ds_read_b64_tr_b16 a[184:185], v30 offset:12288
    v_mfma_f32_32x32x16_bf16 v[96:111], a[108:111], v[184:187], v[96:111]
    ds_read_b64_tr_b16 a[186:187], v30 offset:13312
    ds_read_b64_tr_b16 a[188:189], v31 offset:12288
    ds_read_b64_tr_b16 a[190:191], v31 offset:13312
    v_mfma_f32_32x32x16_bf16 v[48:63], a[112:115], v[188:191], v[48:63]
    v_add_u32 v28, s74, v28
    v_add_u32 v29, s74, v29
    v_add_u32 v30, s74, v30
    v_mfma_f32_32x32x16_bf16 v[64:79], a[116:119], v[188:191], v[64:79]
    v_add_u32 v31, s74, v31
    v_add_u32 v32, s74, v32
    v_add_u32 v33, s74, v33
    v_mfma_f32_32x32x16_bf16 v[80:95], a[120:123], v[188:191], v[80:95]
    v_add_u32 v34, s74, v34
    v_add_u32 v35, s74, v35
    v_mfma_f32_32x32x16_bf16 v[96:111], a[124:127], v[188:191], v[96:111]
    s_add_u32 s73, s73, 2
    s_cmp_lt_u32 s73, 10
    s_waitcnt lgkmcnt(0)
    s_cbranch_scc1 L_q_loop
    s_barrier
    v_mfma_f32_32x32x16_bf16 v[48:63], a[128:131], v[192:195], v[48:63]
    ds_read_b128 v[176:179], v32 offset:0
    ds_read_b128 v[180:183], v33 offset:0
    ds_read_b128 v[184:187], v34 offset:0
    v_mfma_f32_32x32x16_bf16 v[64:79], a[132:135], v[192:195], v[64:79]
    ds_read_b128 v[188:191], v35 offset:0
    ds_read_b64_tr_b16 a[64:65], v28 offset:0
    ds_read_b64_tr_b16 a[66:67], v28 offset:1024
    v_mfma_f32_32x32x16_bf16 v[80:95], a[136:139], v[192:195], v[80:95]
    ds_read_b64_tr_b16 a[68:69], v29 offset:0
    ds_read_b64_tr_b16 a[70:71], v29 offset:1024
    ds_read_b64_tr_b16 a[72:73], v30 offset:0
    v_mfma_f32_32x32x16_bf16 v[96:111], a[140:143], v[192:195], v[96:111]
    ds_read_b64_tr_b16 a[74:75], v30 offset:1024
    ds_read_b64_tr_b16 a[76:77], v31 offset:0
    ds_read_b64_tr_b16 a[78:79], v31 offset:1024
    v_mfma_f32_32x32x16_bf16 v[48:63], a[144:147], v[196:199], v[48:63]
    ds_read_b64_tr_b16 a[80:81], v28 offset:4096
    ds_read_b64_tr_b16 a[82:83], v28 offset:5120
    ds_read_b64_tr_b16 a[84:85], v29 offset:4096
    v_mfma_f32_32x32x16_bf16 v[64:79], a[148:151], v[196:199], v[64:79]
    ds_read_b64_tr_b16 a[86:87], v29 offset:5120
    ds_read_b64_tr_b16 a[88:89], v30 offset:4096
    ds_read_b64_tr_b16 a[90:91], v30 offset:5120
    v_mfma_f32_32x32x16_bf16 v[80:95], a[152:155], v[196:199], v[80:95]
    ds_read_b64_tr_b16 a[92:93], v31 offset:4096
    ds_read_b64_tr_b16 a[94:95], v31 offset:5120
    ds_read_b64_tr_b16 a[96:97], v28 offset:8192
    v_mfma_f32_32x32x16_bf16 v[96:111], a[156:159], v[196:199], v[96:111]
    ds_read_b64_tr_b16 a[98:99], v28 offset:9216
    ds_read_b64_tr_b16 a[100:101], v29 offset:8192
    ds_read_b64_tr_b16 a[102:103], v29 offset:9216
    v_mfma_f32_32x32x16_bf16 v[48:63], a[160:163], v[200:203], v[48:63]
    ds_read_b64_tr_b16 a[104:105], v30 offset:8192
    ds_read_b64_tr_b16 a[106:107], v30 offset:9216
    ds_read_b64_tr_b16 a[108:109], v31 offset:8192
    v_mfma_f32_32x32x16_bf16 v[64:79], a[164:167], v[200:203], v[64:79]
    ds_read_b64_tr_b16 a[110:111], v31 offset:9216
    ds_read_b64_tr_b16 a[112:113], v28 offset:12288
    ds_read_b64_tr_b16 a[114:115], v28 offset:13312
    v_mfma_f32_32x32x16_bf16 v[80:95], a[168:171], v[200:203], v[80:95]
    ds_read_b64_tr_b16 a[116:117], v29 offset:12288
    ds_read_b64_tr_b16 a[118:119], v29 offset:13312
    ds_read_b64_tr_b16 a[120:121], v30 offset:12288
    v_mfma_f32_32x32x16_bf16 v[96:111], a[172:175], v[200:203], v[96:111]
    ds_read_b64_tr_b16 a[122:123], v30 offset:13312
    ds_read_b64_tr_b16 a[124:125], v31 offset:12288
    ds_read_b64_tr_b16 a[126:127], v31 offset:13312
    v_mfma_f32_32x32x16_bf16 v[48:63], a[176:179], v[204:207], v[48:63]
    v_add_u32 v28, 0x8000, v28
    v_add_u32 v29, 0x8000, v29
    v_add_u32 v30, 0x8000, v30
    v_mfma_f32_32x32x16_bf16 v[64:79], a[180:183], v[204:207], v[64:79]
    v_add_u32 v31, 0x8000, v31
    v_add_u32 v32, 0x8000, v32
    v_add_u32 v33, 0x8000, v33
    v_mfma_f32_32x32x16_bf16 v[80:95], a[184:187], v[204:207], v[80:95]
    v_add_u32 v34, 0x8000, v34
    v_add_u32 v35, 0x8000, v35
    v_mfma_f32_32x32x16_bf16 v[96:111], a[188:191], v[204:207], v[96:111]
    s_waitcnt lgkmcnt(0)
    v_mfma_f32_32x32x16_bf16 a[0:15], a[64:67], v[176:179], 0
    ds_read_b128 v[192:195], v32 offset:0
    ds_read_b128 v[196:199], v33 offset:0
    ds_read_b128 v[200:203], v34 offset:0
    v_mfma_f32_32x32x16_bf16 a[16:31], a[68:71], v[176:179], 0
    ds_read_b128 v[204:207], v35 offset:0
    ds_read_b64_tr_b16 a[128:129], v28 offset:0
    ds_read_b64_tr_b16 a[130:131], v28 offset:1024
    v_mfma_f32_32x32x16_bf16 a[32:47], a[72:75], v[176:179], 0
    ds_read_b64_tr_b16 a[132:133], v29 offset:0
    ds_read_b64_tr_b16 a[134:135], v29 offset:1024
    ds_read_b64_tr_b16 a[136:137], v30 offset:0
    v_mfma_f32_32x32x16_bf16 a[48:63], a[76:79], v[176:179], 0
    ds_read_b64_tr_b16 a[138:139], v30 offset:1024
    ds_read_b64_tr_b16 a[140:141], v31 offset:0
    ds_read_b64_tr_b16 a[142:143], v31 offset:1024
    v_mfma_f32_32x32x16_bf16 a[0:15], a[80:83], v[180:183], a[0:15]
    ds_read_b64_tr_b16 a[144:145], v28 offset:4096
    ds_read_b64_tr_b16 a[146:147], v28 offset:5120
    ds_read_b64_tr_b16 a[148:149], v29 offset:4096
    v_mfma_f32_32x32x16_bf16 a[16:31], a[84:87], v[180:183], a[16:31]
    ds_read_b64_tr_b16 a[150:151], v29 offset:5120
    ds_read_b64_tr_b16 a[152:153], v30 offset:4096
    ds_read_b64_tr_b16 a[154:155], v30 offset:5120
    v_mfma_f32_32x32x16_bf16 a[32:47], a[88:91], v[180:183], a[32:47]
    ds_read_b64_tr_b16 a[156:157], v31 offset:4096
    ds_read_b64_tr_b16 a[158:159], v31 offset:5120
    ds_read_b64_tr_b16 a[160:161], v28 offset:8192
    v_mfma_f32_32x32x16_bf16 a[48:63], a[92:95], v[180:183], a[48:63]
    ds_read_b64_tr_b16 a[162:163], v28 offset:9216
    ds_read_b64_tr_b16 a[164:165], v29 offset:8192
    ds_read_b64_tr_b16 a[166:167], v29 offset:9216
    v_mfma_f32_32x32x16_bf16 a[0:15], a[96:99], v[184:187], a[0:15]
    ds_read_b64_tr_b16 a[168:169], v30 offset:8192
    ds_read_b64_tr_b16 a[170:171], v30 offset:9216
    ds_read_b64_tr_b16 a[172:173], v31 offset:8192
    v_mfma_f32_32x32x16_bf16 a[16:31], a[100:103], v[184:187], a[16:31]
    ds_read_b64_tr_b16 a[174:175], v31 offset:9216
    ds_read_b64_tr_b16 a[176:177], v28 offset:12288
    ds_read_b64_tr_b16 a[178:179], v28 offset:13312
    v_mfma_f32_32x32x16_bf16 a[32:47], a[104:107], v[184:187], a[32:47]
    ds_read_b64_tr_b16 a[180:181], v29 offset:12288
    ds_read_b64_tr_b16 a[182:183], v29 offset:13312
    ds_read_b64_tr_b16 a[184:185], v30 offset:12288
    v_mfma_f32_32x32x16_bf16 a[48:63], a[108:111], v[184:187], a[48:63]
    ds_read_b64_tr_b16 a[186:187], v30 offset:13312
    ds_read_b64_tr_b16 a[188:189], v31 offset:12288
    ds_read_b64_tr_b16 a[190:191], v31 offset:13312
    v_mfma_f32_32x32x16_bf16 a[0:15], a[112:115], v[188:191], a[0:15]
    v_mfma_f32_32x32x16_bf16 a[16:31], a[116:119], v[188:191], a[16:31]
    v_mfma_f32_32x32x16_bf16 a[32:47], a[120:123], v[188:191], a[32:47]
    v_mfma_f32_32x32x16_bf16 a[48:63], a[124:127], v[188:191], a[48:63]
    s_waitcnt lgkmcnt(0)
    s_barrier
    v_mfma_f32_32x32x16_bf16 a[0:15], a[128:131], v[192:195], a[0:15]
    ds_read_b128 a[192:195], v16 offset:0
    ds_read_b128 a[196:199], v17 offset:0
    ds_read_b128 a[200:203], v18 offset:0
    ds_read_b128 a[204:207], v19 offset:0
    ds_read_b128 a[208:211], v20 offset:0
    v_mfma_f32_32x32x16_bf16 a[16:31], a[132:135], v[192:195], a[16:31]
    ds_read_b128 a[212:215], v21 offset:0
    ds_read_b128 a[216:219], v22 offset:0
    ds_read_b128 a[220:223], v23 offset:0
    ds_read_b128 a[224:227], v16 offset:8192
    ds_read_b128 a[228:231], v17 offset:8192
    v_mfma_f32_32x32x16_bf16 a[32:47], a[136:139], v[192:195], a[32:47]
    ds_read_b128 a[232:235], v18 offset:8192
    ds_read_b128 a[236:239], v19 offset:8192
    ds_read_b128 a[240:243], v20 offset:8192
    ds_read_b128 a[244:247], v21 offset:8192
    ds_read_b128 a[248:251], v22 offset:8192
    v_mfma_f32_32x32x16_bf16 a[48:63], a[140:143], v[192:195], a[48:63]
    ds_read_b128 a[252:255], v23 offset:8192
    v_pk_mul_f32 v[110:111], v[110:111], s[60:61]
    v_pk_mul_f32 v[108:109], v[108:109], s[60:61]
    v_cvt_pk_bf16_f32 v143, v110, v111
    v_pk_mul_f32 v[106:107], v[106:107], s[60:61]
    v_mfma_f32_32x32x16_bf16 a[0:15], a[144:147], v[196:199], a[0:15]
    v_cvt_pk_bf16_f32 v142, v108, v109
    v_pk_mul_f32 v[104:105], v[104:105], s[60:61]
    v_cvt_pk_bf16_f32 v141, v106, v107
    v_pk_mul_f32 v[102:103], v[102:103], s[60:61]
    v_cvt_pk_bf16_f32 v140, v104, v105
    v_mfma_f32_32x32x16_bf16 a[16:31], a[148:151], v[196:199], a[16:31]
    v_pk_mul_f32 v[100:101], v[100:101], s[60:61]
    v_cvt_pk_bf16_f32 v139, v102, v103
    v_pk_mul_f32 v[98:99], v[98:99], s[60:61]
    v_cvt_pk_bf16_f32 v138, v100, v101
    v_pk_mul_f32 v[96:97], v[96:97], s[60:61]
    v_mfma_f32_32x32x16_bf16 a[32:47], a[152:155], v[196:199], a[32:47]
    v_cvt_pk_bf16_f32 v137, v98, v99
    v_pk_mul_f32 v[94:95], v[94:95], s[60:61]
    v_cvt_pk_bf16_f32 v136, v96, v97
    v_pk_mul_f32 v[92:93], v[92:93], s[60:61]
    v_cvt_pk_bf16_f32 v135, v94, v95
    v_mfma_f32_32x32x16_bf16 a[48:63], a[156:159], v[196:199], a[48:63]
    v_pk_mul_f32 v[90:91], v[90:91], s[60:61]
    v_cvt_pk_bf16_f32 v134, v92, v93
    v_pk_mul_f32 v[88:89], v[88:89], s[60:61]
    v_cvt_pk_bf16_f32 v133, v90, v91
    v_pk_mul_f32 v[86:87], v[86:87], s[60:61]
    v_mfma_f32_32x32x16_bf16 a[0:15], a[160:163], v[200:203], a[0:15]
    v_cvt_pk_bf16_f32 v132, v88, v89
    v_pk_mul_f32 v[84:85], v[84:85], s[60:61]
    v_cvt_pk_bf16_f32 v131, v86, v87
    v_pk_mul_f32 v[82:83], v[82:83], s[60:61]
    v_cvt_pk_bf16_f32 v130, v84, v85
    v_mfma_f32_32x32x16_bf16 a[16:31], a[164:167], v[200:203], a[16:31]
    v_pk_mul_f32 v[80:81], v[80:81], s[60:61]
    v_cvt_pk_bf16_f32 v129, v82, v83
    v_pk_mul_f32 v[78:79], v[78:79], s[60:61]
    v_cvt_pk_bf16_f32 v128, v80, v81
    v_pk_mul_f32 v[76:77], v[76:77], s[60:61]
    v_mfma_f32_32x32x16_bf16 a[32:47], a[168:171], v[200:203], a[32:47]
    v_cvt_pk_bf16_f32 v127, v78, v79
    v_pk_mul_f32 v[74:75], v[74:75], s[60:61]
    v_cvt_pk_bf16_f32 v126, v76, v77
    v_pk_mul_f32 v[72:73], v[72:73], s[60:61]
    v_cvt_pk_bf16_f32 v125, v74, v75
    v_mfma_f32_32x32x16_bf16 a[48:63], a[172:175], v[200:203], a[48:63]
    v_pk_mul_f32 v[70:71], v[70:71], s[60:61]
    v_cvt_pk_bf16_f32 v124, v72, v73
    v_pk_mul_f32 v[68:69], v[68:69], s[60:61]
    v_cvt_pk_bf16_f32 v123, v70, v71
    v_pk_mul_f32 v[66:67], v[66:67], s[60:61]
    v_mfma_f32_32x32x16_bf16 a[0:15], a[176:179], v[204:207], a[0:15]
    v_cvt_pk_bf16_f32 v122, v68, v69
    v_pk_mul_f32 v[64:65], v[64:65], s[60:61]
    v_cvt_pk_bf16_f32 v121, v66, v67
    v_pk_mul_f32 v[62:63], v[62:63], s[60:61]
    v_cvt_pk_bf16_f32 v120, v64, v65
    v_mfma_f32_32x32x16_bf16 a[16:31], a[180:183], v[204:207], a[16:31]
    v_pk_mul_f32 v[60:61], v[60:61], s[60:61]
    v_cvt_pk_bf16_f32 v119, v62, v63
    v_pk_mul_f32 v[58:59], v[58:59], s[60:61]
    v_cvt_pk_bf16_f32 v118, v60, v61
    v_pk_mul_f32 v[56:57], v[56:57], s[60:61]
    v_mfma_f32_32x32x16_bf16 a[32:47], a[184:187], v[204:207], a[32:47]
    v_cvt_pk_bf16_f32 v117, v58, v59
    v_pk_mul_f32 v[54:55], v[54:55], s[60:61]
    v_cvt_pk_bf16_f32 v116, v56, v57
    v_pk_mul_f32 v[52:53], v[52:53], s[60:61]
    v_cvt_pk_bf16_f32 v115, v54, v55
    v_mfma_f32_32x32x16_bf16 a[48:63], a[188:191], v[204:207], a[48:63]
    v_pk_mul_f32 v[50:51], v[50:51], s[60:61]
    v_cvt_pk_bf16_f32 v114, v52, v53
    v_pk_mul_f32 v[48:49], v[48:49], s[60:61]
    v_cvt_pk_bf16_f32 v113, v50, v51
    v_cvt_pk_bf16_f32 v112, v48, v49
    v_pk_mov_b32 v[176:177], 0, 0
    v_pk_mov_b32 v[178:179], 0, 0
    v_pk_mov_b32 v[180:181], 0, 0
    v_pk_mov_b32 v[182:183], 0, 0
    v_pk_mov_b32 v[184:185], 0, 0
    v_pk_mov_b32 v[186:187], 0, 0
    v_pk_mov_b32 v[188:189], 0, 0
    v_pk_mov_b32 v[190:191], 0, 0
    v_pk_mov_b32 v[192:193], 0, 0
    v_pk_mov_b32 v[194:195], 0, 0
    v_pk_mov_b32 v[196:197], 0, 0
    v_pk_mov_b32 v[198:199], 0, 0
    v_pk_mov_b32 v[200:201], 0, 0
    v_pk_mov_b32 v[202:203], 0, 0
    v_pk_mov_b32 v[204:205], 0, 0
    v_pk_mov_b32 v[206:207], 0, 0
    s_call_b64 s[66:67], L_uprol
    v_add_u32 v28, 0xffff8000, v28
    v_add_u32 v29, 0xffff8000, v29
    v_add_u32 v30, 0xffff8000, v30
    v_add_u32 v31, 0xffff8000, v31
    v_add_u32 v32, 0xffff8000, v32
    v_add_u32 v33, 0xffff8000, v33
    v_add_u32 v34, 0xffff8000, v34
    v_add_u32 v35, 0xffff8000, v35
    s_mov_b32 s83, 32768
    s_mov_b32 s81, 1
    s_mov_b32 s74, 32768
    s_mov_b32 s75, 8
    s_call_b64 s[66:67], L_attn_q2
    v_mov_b32 v6, 159744
    ds_read_b32 v7, v6
    s_call_b64 s[66:67], L_uepi
    s_and_b32 s36, s34, 1
    s_cmp_eq_u32 s36, 0
    s_cbranch_scc1 L_ow0_a
    v_add_u32 v4, 98304, v41
    ds_write_b128 v4, v[160:163] offset:0
    ds_write_b128 v4, v[164:167] offset:1024
    ds_write_b128 v4, v[168:171] offset:2048
    ds_write_b128 v4, v[172:175] offset:3072
    s_branch L_ow0_b
L_ow0_a:
    v_add_u32 v4, 98304, v41
    ds_write_b128 v4, v[144:147] offset:0
    ds_write_b128 v4, v[148:151] offset:1024
    ds_write_b128 v4, v[152:155] offset:2048
    ds_write_b128 v4, v[156:159] offset:3072
L_ow0_b:
    s_waitcnt lgkmcnt(0)
    v_readfirstlane_b32 s71, v7
    s_barrier
    s_and_b32 s36, s34, 1
    s_cmp_eq_u32 s36, 0
    s_cbranch_scc1 L_ow1_a
    v_add_u32 v4, 131072, v41
    ds_write_b128 v4, v[144:147] offset:0
    ds_write_b128 v4, v[148:151] offset:1024
    ds_write_b128 v4, v[152:155] offset:2048
    ds_write_b128 v4, v[156:159] offset:3072
    s_branch L_ow1_b
L_ow1_a:
    v_add_u32 v4, 131072, v41
    ds_write_b128 v4, v[160:163] offset:0
    ds_write_b128 v4, v[164:167] offset:1024
    ds_write_b128 v4, v[168:171] offset:2048
    ds_write_b128 v4, v[172:175] offset:3072
L_ow1_b:
    v_accvgpr_read_b32 v240, a0
    v_accvgpr_read_b32 v241, a1
    v_accvgpr_read_b32 v242, a2
    v_accvgpr_read_b32 v243, a3
    v_pk_mul_f32 v[240:241], v[240:241], s[60:61]
    v_accvgpr_read_b32 v244, a4
    v_accvgpr_read_b32 v245, a5
    v_pk_mul_f32 v[242:243], v[242:243], s[60:61]
    v_cvt_pk_bf16_f32 v112, v240, v241
    v_accvgpr_read_b32 v246, a6
    v_accvgpr_read_b32 v247, a7
    v_pk_mul_f32 v[244:245], v[244:245], s[60:61]
    v_cvt_pk_bf16_f32 v113, v242, v243
    v_accvgpr_read_b32 v248, a8
    v_accvgpr_read_b32 v249, a9
    v_pk_mul_f32 v[246:247], v[246:247], s[60:61]
    v_cvt_pk_bf16_f32 v114, v244, v245
    v_accvgpr_read_b32 v250, a10
    v_accvgpr_read_b32 v251, a11
    v_pk_mul_f32 v[248:249], v[248:249], s[60:61]
    v_cvt_pk_bf16_f32 v115, v246, v247
    v_accvgpr_read_b32 v252, a12
    v_accvgpr_read_b32 v253, a13
    v_pk_mul_f32 v[250:251], v[250:251], s[60:61]
    v_cvt_pk_bf16_f32 v116, v248, v249
    v_accvgpr_read_b32 v254, a14
    v_accvgpr_read_b32 v255, a15
    v_pk_mul_f32 v[252:253], v[252:253], s[60:61]
    v_cvt_pk_bf16_f32 v117, v250, v251
    v_accvgpr_read_b32 v240, a16
    v_accvgpr_read_b32 v241, a17
    v_pk_mul_f32 v[254:255], v[254:255], s[60:61]
    v_cvt_pk_bf16_f32 v118, v252, v253
    v_accvgpr_read_b32 v242, a18
    v_accvgpr_read_b32 v243, a19
    v_pk_mul_f32 v[240:241], v[240:241], s[60:61]
    v_cvt_pk_bf16_f32 v119, v254, v255
    v_accvgpr_read_b32 v244, a20
    v_accvgpr_read_b32 v245, a21
    v_pk_mul_f32 v[242:243], v[242:243], s[60:61]
    v_cvt_pk_bf16_f32 v120, v240, v241
    v_accvgpr_read_b32 v246, a22
    v_accvgpr_read_b32 v247, a23
    v_pk_mul_f32 v[244:245], v[244:245], s[60:61]
    v_cvt_pk_bf16_f32 v121, v242, v243
    v_accvgpr_read_b32 v248, a24
    v_accvgpr_read_b32 v249, a25
    v_pk_mul_f32 v[246:247], v[246:247], s[60:61]
    v_cvt_pk_bf16_f32 v122, v244, v245
    v_accvgpr_read_b32 v250, a26
    v_accvgpr_read_b32 v251, a27
    v_pk_mul_f32 v[248:249], v[248:249], s[60:61]
    v_cvt_pk_bf16_f32 v123, v246, v247
    v_accvgpr_read_b32 v252, a28
    v_accvgpr_read_b32 v253, a29
    v_pk_mul_f32 v[250:251], v[250:251], s[60:61]
    v_cvt_pk_bf16_f32 v124, v248, v249
    v_accvgpr_read_b32 v254, a30
    v_accvgpr_read_b32 v255, a31
    v_pk_mul_f32 v[252:253], v[252:253], s[60:61]
    v_cvt_pk_bf16_f32 v125, v250, v251
    v_accvgpr_read_b32 v240, a32
    v_accvgpr_read_b32 v241, a33
    v_pk_mul_f32 v[254:255], v[254:255], s[60:61]
    v_cvt_pk_bf16_f32 v126, v252, v253
    v_accvgpr_read_b32 v242, a34
    v_accvgpr_read_b32 v243, a35
    v_pk_mul_f32 v[240:241], v[240:241], s[60:61]
    v_cvt_pk_bf16_f32 v127, v254, v255
    v_accvgpr_read_b32 v244, a36
    v_accvgpr_read_b32 v245, a37
    v_pk_mul_f32 v[242:243], v[242:243], s[60:61]
    v_cvt_pk_bf16_f32 v128, v240, v241
    v_accvgpr_read_b32 v246, a38
    v_accvgpr_read_b32 v247, a39
    v_pk_mul_f32 v[244:245], v[244:245], s[60:61]
    v_cvt_pk_bf16_f32 v129, v242, v243
    v_accvgpr_read_b32 v248, a40
    v_accvgpr_read_b32 v249, a41
    v_pk_mul_f32 v[246:247], v[246:247], s[60:61]
    v_cvt_pk_bf16_f32 v130, v244, v245
    v_accvgpr_read_b32 v250, a42
    v_accvgpr_read_b32 v251, a43
    v_pk_mul_f32 v[248:249], v[248:249], s[60:61]
    v_cvt_pk_bf16_f32 v131, v246, v247
    v_accvgpr_read_b32 v252, a44
    v_accvgpr_read_b32 v253, a45
    v_pk_mul_f32 v[250:251], v[250:251], s[60:61]
    v_cvt_pk_bf16_f32 v132, v248, v249
    v_accvgpr_read_b32 v254, a46
    v_accvgpr_read_b32 v255, a47
    v_pk_mul_f32 v[252:253], v[252:253], s[60:61]
    v_cvt_pk_bf16_f32 v133, v250, v251
    v_accvgpr_read_b32 v240, a48
    v_accvgpr_read_b32 v241, a49
    v_pk_mul_f32 v[254:255], v[254:255], s[60:61]
    v_cvt_pk_bf16_f32 v134, v252, v253
    v_accvgpr_read_b32 v242, a50
    v_accvgpr_read_b32 v243, a51
    v_pk_mul_f32 v[240:241], v[240:241], s[60:61]
    v_cvt_pk_bf16_f32 v135, v254, v255
    v_accvgpr_read_b32 v244, a52
    v_accvgpr_read_b32 v245, a53
    v_pk_mul_f32 v[242:243], v[242:243], s[60:61]
    v_cvt_pk_bf16_f32 v136, v240, v241
    v_accvgpr_read_b32 v246, a54
    v_accvgpr_read_b32 v247, a55
    v_pk_mul_f32 v[244:245], v[244:245], s[60:61]
    v_cvt_pk_bf16_f32 v137, v242, v243
    v_accvgpr_read_b32 v248, a56
    v_accvgpr_read_b32 v249, a57
    v_pk_mul_f32 v[246:247], v[246:247], s[60:61]
    v_cvt_pk_bf16_f32 v138, v244, v245
    v_accvgpr_read_b32 v250, a58
    v_accvgpr_read_b32 v251, a59
    v_pk_mul_f32 v[248:249], v[248:249], s[60:61]
    v_cvt_pk_bf16_f32 v139, v246, v247
    v_accvgpr_read_b32 v252, a60
    v_accvgpr_read_b32 v253, a61
    v_pk_mul_f32 v[250:251], v[250:251], s[60:61]
    v_cvt_pk_bf16_f32 v140, v248, v249
    v_accvgpr_read_b32 v254, a62
    v_accvgpr_read_b32 v255, a63
    v_pk_mul_f32 v[252:253], v[252:253], s[60:61]
    v_cvt_pk_bf16_f32 v141, v250, v251
    v_pk_mul_f32 v[254:255], v[254:255], s[60:61]
    v_cvt_pk_bf16_f32 v142, v252, v253
    v_cvt_pk_bf16_f32 v143, v254, v255
    s_waitcnt vmcnt(0)
    s_lshl_b32 s38, s35, 2
    s_lshl_b32 s39, s3, 4
    s_add_u32 s38, s38, s39
    s_add_u32 s38, s38, s64
    v_mov_b32 v44, s71
    s_mov_b64 exec, 1
    buffer_store_dword v44, v43, s[24:27], s38 offen sc1
    s_mov_b64 exec, -1
    s_mov_b32 s72, 1
    s_add_u32 s70, s70, 4
    v_pk_mov_b32 v[176:177], 0, 0
    v_pk_mov_b32 v[178:179], 0, 0
    v_pk_mov_b32 v[180:181], 0, 0
    v_pk_mov_b32 v[182:183], 0, 0
    v_pk_mov_b32 v[184:185], 0, 0
    v_pk_mov_b32 v[186:187], 0, 0
    v_pk_mov_b32 v[188:189], 0, 0
    v_pk_mov_b32 v[190:191], 0, 0
    v_pk_mov_b32 v[192:193], 0, 0
    v_pk_mov_b32 v[194:195], 0, 0
    v_pk_mov_b32 v[196:197], 0, 0
    v_pk_mov_b32 v[198:199], 0, 0
    v_pk_mov_b32 v[200:201], 0, 0
    v_pk_mov_b32 v[202:203], 0, 0
    v_pk_mov_b32 v[204:205], 0, 0
    v_pk_mov_b32 v[206:207], 0, 0
    v_pk_mov_b32 v[208:209], 0, 0
    v_pk_mov_b32 v[210:211], 0, 0
    v_pk_mov_b32 v[212:213], 0, 0
    v_pk_mov_b32 v[214:215], 0, 0
    v_pk_mov_b32 v[216:217], 0, 0
    v_pk_mov_b32 v[218:219], 0, 0
    v_pk_mov_b32 v[220:221], 0, 0
    v_pk_mov_b32 v[222:223], 0, 0
    v_pk_mov_b32 v[224:225], 0, 0
    v_pk_mov_b32 v[226:227], 0, 0
    v_pk_mov_b32 v[228:229], 0, 0
    v_pk_mov_b32 v[230:231], 0, 0
    v_pk_mov_b32 v[232:233], 0, 0
    v_pk_mov_b32 v[234:235], 0, 0
    v_pk_mov_b32 v[236:237], 0, 0
    v_pk_mov_b32 v[238:239], 0, 0
    s_call_b64 s[66:67], L_uprol
    v_mfma_f32_32x32x16_bf16 a[0:15], v[104:107], v[108:111], 0
    v_mfma_f32_32x32x16_bf16 a[16:31], v[104:107], v[108:111], 0
    v_mfma_f32_32x32x16_bf16 a[32:47], v[104:107], v[108:111], 0
    v_mfma_f32_32x32x16_bf16 a[48:63], v[104:107], v[108:111], 0
    v_mfma_f32_32x32x16_bf16 a[64:79], v[104:107], v[108:111], 0
    s_mov_b32 s75, 8
    s_mov_b32 s83, 98304
    s_call_b64 s[66:67], L_attn_oa
    s_waitcnt lgkmcnt(0)
    s_barrier
    v_add_u32 v4, 81920, v40
    v_add_u32 v5, 102400, v40
    ds_read_b64_tr_b16 a[80:81], v4 offset:0
    ds_read_b64_tr_b16 a[82:83], v4 offset:1280
    ds_read_b64_tr_b16 a[84:85], v4 offset:64
    ds_read_b64_tr_b16 a[86:87], v4 offset:1344
    ds_read_b64_tr_b16 a[88:89], v4 offset:128
    ds_read_b64_tr_b16 a[90:91], v4 offset:1408
    ds_read_b64_tr_b16 a[92:93], v4 offset:192
    ds_read_b64_tr_b16 a[94:95], v4 offset:1472
    ds_read_b64_tr_b16 a[96:97], v4 offset:256
    ds_read_b64_tr_b16 a[98:99], v4 offset:1536
    ds_read_b64_tr_b16 a[100:101], v4 offset:5120
    ds_read_b64_tr_b16 a[102:103], v4 offset:6400
    ds_read_b64_tr_b16 a[104:105], v4 offset:5184
    ds_read_b64_tr_b16 a[106:107], v4 offset:6464
    ds_read_b64_tr_b16 a[108:109], v4 offset:5248
    ds_read_b64_tr_b16 a[110:111], v4 offset:6528
    ds_read_b64_tr_b16 a[112:113], v4 offset:5312
    ds_read_b64_tr_b16 a[114:115], v4 offset:6592
    ds_read_b64_tr_b16 a[116:117], v4 offset:5376
    ds_read_b64_tr_b16 a[118:119], v4 offset:6656
    s_call_b64 s[66:67], L_uepi
    s_barrier
    s_call_b64 s[66:67], L_own
    s_barrier
    s_lshl_b32 s36, s32, 3
    s_add_u32 s36, s36, s34
    s_lshl_b32 s36, s36, 2
    s_add_u32 s36, s36, s35
    s_mul_i32 s79, s36, 245760
    s_add_u32 s79, s79, 16777216
    s_mul_i32 s38, s3, 5120
    s_add_u32 s79, s79, s38
    s_mul_i32 s38, s33, 15360
    s_add_u32 s80, s79, s38
    v_add_u32 v2, 122880, v40
    v_add_u32 v3, 143360, v40
    v_add_u32 v4, 0, v40
    v_add_u32 v5, 20480, v40
    v_add_u32 v6, 40960, v40
    v_add_u32 v7, 61440, v40
    s_lshl_b32 s39, s3, 4
    s_add_u32 s39, s39, s64
    s_add_u32 s39, s39, 16384
    s_mov_b32 s37, 0
    v_and_b32 v8, 3, v1
    v_lshlrev_b32 v8, 2, v8
    buffer_load_dword v44, v8, s[24:27], s39 offen sc1
L_pw_f2:
    s_waitcnt vmcnt(0)
    v_cmp_ne_u32 vcc, s71, v44
    s_nop 0
    s_cbranch_vccz L_pw_f2_done
    buffer_load_dword v44, v8, s[24:27], s39 offen sc1
    s_add_u32 s37, s37, 1
    s_cmp_lt_u32 s37, 50000
    s_cbranch_scc1 L_pw_f2
L_pw_f2_done:
    s_lshl_b32 s36, s32, 3
    s_add_u32 s36, s36, s34
    s_lshl_b32 s36, s36, 5
    s_lshl_b32 s37, s33, 3
    s_add_u32 s36, s36, s37
    s_add_u32 s36, s36, 4
    s_add_u32 s37, s35, 1
    s_and_b32 s37, s37, 3
    s_add_u32 s37, s37, s36
    s_mul_i32 s37, s37, 3
    s_add_u32 s37, s37, s3
    s_lshl_b32 s37, s37, 13
    buffer_load_dwordx4 v[48:51], v42, s[24:27], s37 offen offset:0
    buffer_load_dwordx4 v[52:55], v42, s[24:27], s37 offen offset:1024
    buffer_load_dwordx4 v[56:59], v42, s[24:27], s37 offen offset:2048
    buffer_load_dwordx4 v[60:63], v42, s[24:27], s37 offen offset:3072
    s_add_u32 s37, s37, 4096
    buffer_load_dwordx4 v[64:67], v42, s[24:27], s37 offen offset:0
    buffer_load_dwordx4 v[68:71], v42, s[24:27], s37 offen offset:1024
    buffer_load_dwordx4 v[72:75], v42, s[24:27], s37 offen offset:2048
    buffer_load_dwordx4 v[76:79], v42, s[24:27], s37 offen offset:3072
    s_add_u32 s37, s35, 2
    s_and_b32 s37, s37, 3
    s_add_u32 s37, s37, s36
    s_mul_i32 s37, s37, 3
    s_add_u32 s37, s37, s3
    s_lshl_b32 s37, s37, 13
    buffer_load_dwordx4 v[80:83], v42, s[24:27], s37 offen offset:0
    buffer_load_dwordx4 v[84:87], v42, s[24:27], s37 offen offset:1024
    buffer_load_dwordx4 v[88:91], v42, s[24:27], s37 offen offset:2048
    buffer_load_dwordx4 v[92:95], v42, s[24:27], s37 offen offset:3072
    s_add_u32 s37, s37, 4096
    buffer_load_dwordx4 v[96:99], v42, s[24:27], s37 offen offset:0
    buffer_load_dwordx4 v[100:103], v42, s[24:27], s37 offen offset:1024
    buffer_load_dwordx4 v[104:107], v42, s[24:27], s37 offen offset:2048
    buffer_load_dwordx4 v[108:111], v42, s[24:27], s37 offen offset:3072
    s_add_u32 s37, s35, 3
    s_and_b32 s37, s37, 3
    s_add_u32 s37, s37, s36
    s_mul_i32 s37, s37, 3
    s_add_u32 s37, s37, s3
    s_lshl_b32 s37, s37, 13
    buffer_load_dwordx4 v[112:115], v42, s[24:27], s37 offen offset:0
    buffer_load_dwordx4 v[116:119], v42, s[24:27], s37 offen offset:1024
    buffer_load_dwordx4 v[120:123], v42, s[24:27], s37 offen offset:2048
    buffer_load_dwordx4 v[124:127], v42, s[24:27], s37 offen offset:3072
    s_add_u32 s37, s37, 4096
    buffer_load_dwordx4 v[128:131], v42, s[24:27], s37 offen offset:0
    buffer_load_dwordx4 v[132:135], v42, s[24:27], s37 offen offset:1024
    buffer_load_dwordx4 v[136:139], v42, s[24:27], s37 offen offset:2048
    buffer_load_dwordx4 v[140:143], v42, s[24:27], s37 offen offset:3072
    s_cmp_eq_u32 s33, 0
    s_cbranch_scc0 L_tm_skip0
    ds_read_b64_tr_b16 a[80:81], v2 offset:256
    ds_read_b64_tr_b16 a[82:83], v2 offset:1536
    ds_read_b64_tr_b16 a[84:85], v2 offset:64
    ds_read_b64_tr_b16 a[86:87], v2 offset:1344
    ds_read_b64_tr_b16 a[88:89], v2 offset:5376
    ds_read_b64_tr_b16 a[90:91], v2 offset:6656
    ds_read_b64_tr_b16 a[92:93], v2 offset:5184
    ds_read_b64_tr_b16 a[94:95], v2 offset:6464
    ds_read_b64_tr_b16 a[96:97], v2 offset:10496
    ds_read_b64_tr_b16 a[98:99], v2 offset:11776
    ds_read_b64_tr_b16 a[100:101], v2 offset:10304
    ds_read_b64_tr_b16 a[102:103], v2 offset:11584
    s_waitcnt lgkmcnt(10)
    s_waitcnt vmcnt(16)
    v_mfma_f32_32x32x16_bf16 a[64:79], a[80:83], v[48:51], a[64:79]
    ds_read_b64_tr_b16 a[104:105], v2 offset:15616
    ds_read_b64_tr_b16 a[106:107], v2 offset:16896
    s_waitcnt lgkmcnt(10)
    v_mfma_f32_32x32x16_bf16 a[16:31], a[84:87], v[48:51], a[16:31]
    ds_read_b64_tr_b16 a[108:109], v2 offset:15424
    ds_read_b64_tr_b16 a[110:111], v2 offset:16704
    s_waitcnt lgkmcnt(10)
    v_mfma_f32_32x32x16_bf16 a[64:79], a[88:91], v[52:55], a[64:79]
    ds_read_b64_tr_b16 a[80:81], v3 offset:256
    ds_read_b64_tr_b16 a[82:83], v3 offset:1536
    s_waitcnt lgkmcnt(10)
    v_mfma_f32_32x32x16_bf16 a[16:31], a[92:95], v[52:55], a[16:31]
    ds_read_b64_tr_b16 a[84:85], v3 offset:64
    ds_read_b64_tr_b16 a[86:87], v3 offset:1344
    s_waitcnt lgkmcnt(10)
    v_mfma_f32_32x32x16_bf16 a[64:79], a[96:99], v[56:59], a[64:79]
    ds_read_b64_tr_b16 a[88:89], v3 offset:5376
    ds_read_b64_tr_b16 a[90:91], v3 offset:6656
    s_waitcnt lgkmcnt(10)
    v_mfma_f32_32x32x16_bf16 a[16:31], a[100:103], v[56:59], a[16:31]
    ds_read_b64_tr_b16 a[92:93], v3 offset:5184
    ds_read_b64_tr_b16 a[94:95], v3 offset:6464
    s_waitcnt lgkmcnt(10)
    v_mfma_f32_32x32x16_bf16 a[64:79], a[104:107], v[60:63], a[64:79]
    ds_read_b64_tr_b16 a[96:97], v3 offset:10496
    ds_read_b64_tr_b16 a[98:99], v3 offset:11776
    s_waitcnt lgkmcnt(10)
    v_mfma_f32_32x32x16_bf16 a[16:31], a[108:111], v[60:63], a[16:31]
    ds_read_b64_tr_b16 a[100:101], v3 offset:10304
    ds_read_b64_tr_b16 a[102:103], v3 offset:11584
    s_waitcnt lgkmcnt(10)
    v_mfma_f32_32x32x16_bf16 a[64:79], a[80:83], v[64:67], a[64:79]
    ds_read_b64_tr_b16 a[104:105], v3 offset:15616
    ds_read_b64_tr_b16 a[106:107], v3 offset:16896
    s_waitcnt lgkmcnt(10)
    v_mfma_f32_32x32x16_bf16 a[16:31], a[84:87], v[64:67], a[16:31]
    ds_read_b64_tr_b16 a[108:109], v3 offset:15424
    ds_read_b64_tr_b16 a[110:111], v3 offset:16704
    s_waitcnt lgkmcnt(10)
    v_mfma_f32_32x32x16_bf16 a[64:79], a[88:91], v[68:71], a[64:79]
    ds_read_b64_tr_b16 a[80:81], v4 offset:256
    ds_read_b64_tr_b16 a[82:83], v4 offset:1536
    s_waitcnt lgkmcnt(10)
    v_mfma_f32_32x32x16_bf16 a[16:31], a[92:95], v[68:71], a[16:31]
    ds_read_b64_tr_b16 a[84:85], v4 offset:64
    ds_read_b64_tr_b16 a[86:87], v4 offset:1344
    s_waitcnt lgkmcnt(10)
    v_mfma_f32_32x32x16_bf16 a[64:79], a[96:99], v[72:75], a[64:79]
    ds_read_b64_tr_b16 a[88:89], v4 offset:5376
    ds_read_b64_tr_b16 a[90:91], v4 offset:6656
    s_waitcnt lgkmcnt(10)
    v_mfma_f32_32x32x16_bf16 a[16:31], a[100:103], v[72:75], a[16:31]
    ds_read_b64_tr_b16 a[92:93], v4 offset:5184
    ds_read_b64_tr_b16 a[94:95], v4 offset:6464
    s_waitcnt lgkmcnt(10)
    v_mfma_f32_32x32x16_bf16 a[64:79], a[104:107], v[76:79], a[64:79]
    ds_read_b64_tr_b16 a[96:97], v4 offset:10496
    ds_read_b64_tr_b16 a[98:99], v4 offset:11776
    s_waitcnt lgkmcnt(10)
    v_mfma_f32_32x32x16_bf16 a[16:31], a[108:111], v[76:79], a[16:31]
    ds_read_b64_tr_b16 a[100:101], v4 offset:10304
    ds_read_b64_tr_b16 a[102:103], v4 offset:11584
    s_waitcnt lgkmcnt(10)
    s_waitcnt vmcnt(8)
    v_mfma_f32_32x32x16_bf16 a[64:79], a[80:83], v[80:83], a[64:79]
    ds_read_b64_tr_b16 a[104:105], v4 offset:15616
    ds_read_b64_tr_b16 a[106:107], v4 offset:16896
    s_waitcnt lgkmcnt(10)
    v_mfma_f32_32x32x16_bf16 a[16:31], a[84:87], v[80:83], a[16:31]
    ds_read_b64_tr_b16 a[108:109], v4 offset:15424
    ds_read_b64_tr_b16 a[110:111], v4 offset:16704
    s_waitcnt lgkmcnt(10)
    v_mfma_f32_32x32x16_bf16 a[64:79], a[88:91], v[84:87], a[64:79]
    ds_read_b64_tr_b16 a[80:81], v5 offset:256
    ds_read_b64_tr_b16 a[82:83], v5 offset:1536
    s_waitcnt lgkmcnt(10)
    v_mfma_f32_32x32x16_bf16 a[16:31], a[92:95], v[84:87], a[16:31]
    ds_read_b64_tr_b16 a[84:85], v5 offset:64
    ds_read_b64_tr_b16 a[86:87], v5 offset:1344
    s_waitcnt lgkmcnt(10)
    v_mfma_f32_32x32x16_bf16 a[64:79], a[96:99], v[88:91], a[64:79]
    ds_read_b64_tr_b16 a[88:89], v5 offset:5376
    ds_read_b64_tr_b16 a[90:91], v5 offset:6656
    s_waitcnt lgkmcnt(10)
    v_mfma_f32_32x32x16_bf16 a[16:31], a[100:103], v[88:91], a[16:31]
    ds_read_b64_tr_b16 a[92:93], v5 offset:5184
    ds_read_b64_tr_b16 a[94:95], v5 offset:6464
    s_waitcnt lgkmcnt(10)
    v_mfma_f32_32x32x16_bf16 a[64:79], a[104:107], v[92:95], a[64:79]
    ds_read_b64_tr_b16 a[96:97], v5 offset:10496
    ds_read_b64_tr_b16 a[98:99], v5 offset:11776
    s_waitcnt lgkmcnt(10)
    v_mfma_f32_32x32x16_bf16 a[16:31], a[108:111], v[92:95], a[16:31]
    ds_read_b64_tr_b16 a[100:101], v5 offset:10304
    ds_read_b64_tr_b16 a[102:103], v5 offset:11584
    s_waitcnt lgkmcnt(10)
    v_mfma_f32_32x32x16_bf16 a[64:79], a[80:83], v[96:99], a[64:79]
    ds_read_b64_tr_b16 a[104:105], v5 offset:15616
    ds_read_b64_tr_b16 a[106:107], v5 offset:16896
    s_waitcnt lgkmcnt(10)
    v_mfma_f32_32x32x16_bf16 a[16:31], a[84:87], v[96:99], a[16:31]
    ds_read_b64_tr_b16 a[108:109], v5 offset:15424
    ds_read_b64_tr_b16 a[110:111], v5 offset:16704
    s_waitcnt lgkmcnt(10)
    v_mfma_f32_32x32x16_bf16 a[64:79], a[88:91], v[100:103], a[64:79]
    ds_read_b64_tr_b16 a[80:81], v6 offset:256
    ds_read_b64_tr_b16 a[82:83], v6 offset:1536
    s_waitcnt lgkmcnt(10)
    v_mfma_f32_32x32x16_bf16 a[16:31], a[92:95], v[100:103], a[16:31]
    ds_read_b64_tr_b16 a[84:85], v6 offset:64
    ds_read_b64_tr_b16 a[86:87], v6 offset:1344
    s_waitcnt lgkmcnt(10)
    v_mfma_f32_32x32x16_bf16 a[64:79], a[96:99], v[104:107], a[64:79]
    ds_read_b64_tr_b16 a[88:89], v6 offset:5376
    ds_read_b64_tr_b16 a[90:91], v6 offset:6656
    s_waitcnt lgkmcnt(10)
    v_mfma_f32_32x32x16_bf16 a[16:31], a[100:103], v[104:107], a[16:31]
    ds_read_b64_tr_b16 a[92:93], v6 offset:5184
    ds_read_b64_tr_b16 a[94:95], v6 offset:6464
    s_waitcnt lgkmcnt(10)
    v_mfma_f32_32x32x16_bf16 a[64:79], a[104:107], v[108:111], a[64:79]
    ds_read_b64_tr_b16 a[96:97], v6 offset:10496
    ds_read_b64_tr_b16 a[98:99], v6 offset:11776
    s_waitcnt lgkmcnt(10)
    v_mfma_f32_32x32x16_bf16 a[16:31], a[108:111], v[108:111], a[16:31]
    ds_read_b64_tr_b16 a[100:101], v6 offset:10304
    ds_read_b64_tr_b16 a[102:103], v6 offset:11584
    s_waitcnt lgkmcnt(10)
    s_waitcnt vmcnt(0)
    v_mfma_f32_32x32x16_bf16 a[64:79], a[80:83], v[112:115], a[64:79]
    ds_read_b64_tr_b16 a[104:105], v6 offset:15616
    ds_read_b64_tr_b16 a[106:107], v6 offset:16896
    s_waitcnt lgkmcnt(10)
    v_mfma_f32_32x32x16_bf16 a[16:31], a[84:87], v[112:115], a[16:31]
    ds_read_b64_tr_b16 a[108:109], v6 offset:15424
    ds_read_b64_tr_b16 a[110:111], v6 offset:16704
    s_waitcnt lgkmcnt(10)
    v_mfma_f32_32x32x16_bf16 a[64:79], a[88:91], v[116:119], a[64:79]
    ds_read_b64_tr_b16 a[80:81], v7 offset:256
    ds_read_b64_tr_b16 a[82:83], v7 offset:1536
    s_waitcnt lgkmcnt(10)
    v_mfma_f32_32x32x16_bf16 a[16:31], a[92:95], v[116:119], a[16:31]
    ds_read_b64_tr_b16 a[84:85], v7 offset:64
    ds_read_b64_tr_b16 a[86:87], v7 offset:1344
    s_waitcnt lgkmcnt(10)
    v_mfma_f32_32x32x16_bf16 a[64:79], a[96:99], v[120:123], a[64:79]
    ds_read_b64_tr_b16 a[88:89], v7 offset:5376
    ds_read_b64_tr_b16 a[90:91], v7 offset:6656
    s_waitcnt lgkmcnt(10)
    v_mfma_f32_32x32x16_bf16 a[16:31], a[100:103], v[120:123], a[16:31]
    ds_read_b64_tr_b16 a[92:93], v7 offset:5184
    ds_read_b64_tr_b16 a[94:95], v7 offset:6464
    s_waitcnt lgkmcnt(10)
    v_mfma_f32_32x32x16_bf16 a[64:79], a[104:107], v[124:127], a[64:79]
    ds_read_b64_tr_b16 a[96:97], v7 offset:10496
    ds_read_b64_tr_b16 a[98:99], v7 offset:11776
    s_waitcnt lgkmcnt(10)
    v_mfma_f32_32x32x16_bf16 a[16:31], a[108:111], v[124:127], a[16:31]
    ds_read_b64_tr_b16 a[100:101], v7 offset:10304
    ds_read_b64_tr_b16 a[102:103], v7 offset:11584
    s_waitcnt lgkmcnt(10)
    v_mfma_f32_32x32x16_bf16 a[64:79], a[80:83], v[128:131], a[64:79]
    ds_read_b64_tr_b16 a[104:105], v7 offset:15616
    ds_read_b64_tr_b16 a[106:107], v7 offset:16896
    s_waitcnt lgkmcnt(10)
    v_mfma_f32_32x32x16_bf16 a[16:31], a[84:87], v[128:131], a[16:31]
    ds_read_b64_tr_b16 a[108:109], v7 offset:15424
    ds_read_b64_tr_b16 a[110:111], v7 offset:16704
    s_waitcnt lgkmcnt(10)
    v_mfma_f32_32x32x16_bf16 a[64:79], a[88:91], v[132:135], a[64:79]
    ds_read_b64_tr_b16 a[80:81], v2 offset:128
    ds_read_b64_tr_b16 a[82:83], v2 offset:1408
    s_waitcnt lgkmcnt(10)
    v_mfma_f32_32x32x16_bf16 a[16:31], a[92:95], v[132:135], a[16:31]
    ds_read_b64_tr_b16 a[84:85], v2 offset:192
    ds_read_b64_tr_b16 a[86:87], v2 offset:1472
    s_waitcnt lgkmcnt(10)
    v_mfma_f32_32x32x16_bf16 a[64:79], a[96:99], v[136:139], a[64:79]
    ds_read_b64_tr_b16 a[88:89], v2 offset:5248
    ds_read_b64_tr_b16 a[90:91], v2 offset:6528
    s_waitcnt lgkmcnt(10)
    v_mfma_f32_32x32x16_bf16 a[16:31], a[100:103], v[136:139], a[16:31]
    ds_read_b64_tr_b16 a[92:93], v2 offset:5312
    ds_read_b64_tr_b16 a[94:95], v2 offset:6592
    s_waitcnt lgkmcnt(10)
    v_mfma_f32_32x32x16_bf16 a[64:79], a[104:107], v[140:143], a[64:79]
    ds_read_b64_tr_b16 a[96:97], v2 offset:10368
    ds_read_b64_tr_b16 a[98:99], v2 offset:11648
    s_waitcnt lgkmcnt(10)
    v_mfma_f32_32x32x16_bf16 a[16:31], a[108:111], v[140:143], a[16:31]
    ds_read_b64_tr_b16 a[100:101], v2 offset:10432
    ds_read_b64_tr_b16 a[102:103], v2 offset:11712
    s_waitcnt lgkmcnt(10)
    v_mfma_f32_32x32x16_bf16 a[32:47], a[80:83], v[48:51], a[32:47]
    ds_read_b64_tr_b16 a[104:105], v2 offset:15488
    ds_read_b64_tr_b16 a[106:107], v2 offset:16768
    s_waitcnt lgkmcnt(10)
    v_mfma_f32_32x32x16_bf16 a[48:63], a[84:87], v[48:51], a[48:63]
    ds_read_b64_tr_b16 a[108:109], v2 offset:15552
    ds_read_b64_tr_b16 a[110:111], v2 offset:16832
    s_waitcnt lgkmcnt(10)
    v_mfma_f32_32x32x16_bf16 a[32:47], a[88:91], v[52:55], a[32:47]
    ds_read_b64_tr_b16 a[80:81], v3 offset:128
    ds_read_b64_tr_b16 a[82:83], v3 offset:1408
    s_waitcnt lgkmcnt(10)
    v_mfma_f32_32x32x16_bf16 a[48:63], a[92:95], v[52:55], a[48:63]
    ds_read_b64_tr_b16 a[84:85], v3 offset:192
    ds_read_b64_tr_b16 a[86:87], v3 offset:1472
    s_waitcnt lgkmcnt(10)
    v_mfma_f32_32x32x16_bf16 a[32:47], a[96:99], v[56:59], a[32:47]
    ds_read_b64_tr_b16 a[88:89], v3 offset:5248
    ds_read_b64_tr_b16 a[90:91], v3 offset:6528
    s_waitcnt lgkmcnt(10)
    v_mfma_f32_32x32x16_bf16 a[48:63], a[100:103], v[56:59], a[48:63]
    ds_read_b64_tr_b16 a[92:93], v3 offset:5312
    ds_read_b64_tr_b16 a[94:95], v3 offset:6592
    s_add_u32 s38, s80, 65536
    buffer_store_dwordx4 a[68:71], v42, s[24:27], s38 offen sc1
    s_add_u32 s38, s80, 126976
    s_waitcnt lgkmcnt(10)
    v_mfma_f32_32x32x16_bf16 a[32:47], a[104:107], v[60:63], a[32:47]
    ds_read_b64_tr_b16 a[96:97], v3 offset:10368
    ds_read_b64_tr_b16 a[98:99], v3 offset:11648
    buffer_store_dwordx4 a[72:75], v42, s[24:27], s38 offen sc1
    s_add_u32 s38, s80, 188416
    buffer_store_dwordx4 a[76:79], v42, s[24:27], s38 offen sc1
    s_waitcnt lgkmcnt(10)
    v_mfma_f32_32x32x16_bf16 a[48:63], a[108:111], v[60:63], a[48:63]
    ds_read_b64_tr_b16 a[100:101], v3 offset:10432
    ds_read_b64_tr_b16 a[102:103], v3 offset:11712
    s_add_u32 s38, s80, 61440
    buffer_store_dwordx4 a[16:19], v42, s[24:27], s38 offen offset:0 sc1
    buffer_store_dwordx4 a[20:23], v42, s[24:27], s38 offen offset:1024 sc1
    s_waitcnt lgkmcnt(10)
    v_mfma_f32_32x32x16_bf16 a[32:47], a[80:83], v[64:67], a[32:47]
    ds_read_b64_tr_b16 a[104:105], v3 offset:15488
    ds_read_b64_tr_b16 a[106:107], v3 offset:16768
    buffer_store_dwordx4 a[24:27], v42, s[24:27], s38 offen offset:2048 sc1
    buffer_store_dwordx4 a[28:31], v42, s[24:27], s38 offen offset:3072 sc1
    s_waitcnt lgkmcnt(10)
    v_mfma_f32_32x32x16_bf16 a[48:63], a[84:87], v[64:67], a[48:63]
    ds_read_b64_tr_b16 a[108:109], v3 offset:15552
    ds_read_b64_tr_b16 a[110:111], v3 offset:16832
    s_waitcnt lgkmcnt(10)
    v_mfma_f32_32x32x16_bf16 a[32:47], a[88:91], v[68:71], a[32:47]
    ds_read_b64_tr_b16 a[80:81], v4 offset:128
    ds_read_b64_tr_b16 a[82:83], v4 offset:1408
    s_waitcnt lgkmcnt(10)
    v_mfma_f32_32x32x16_bf16 a[48:63], a[92:95], v[68:71], a[48:63]
    ds_read_b64_tr_b16 a[84:85], v4 offset:192
    ds_read_b64_tr_b16 a[86:87], v4 offset:1472
    s_waitcnt lgkmcnt(10)
    v_mfma_f32_32x32x16_bf16 a[32:47], a[96:99], v[72:75], a[32:47]
    ds_read_b64_tr_b16 a[88:89], v4 offset:5248
    ds_read_b64_tr_b16 a[90:91], v4 offset:6528
    s_waitcnt lgkmcnt(10)
    v_mfma_f32_32x32x16_bf16 a[48:63], a[100:103], v[72:75], a[48:63]
    ds_read_b64_tr_b16 a[92:93], v4 offset:5312
    ds_read_b64_tr_b16 a[94:95], v4 offset:6592
    s_waitcnt lgkmcnt(10)
    v_mfma_f32_32x32x16_bf16 a[32:47], a[104:107], v[76:79], a[32:47]
    ds_read_b64_tr_b16 a[96:97], v4 offset:10368
    ds_read_b64_tr_b16 a[98:99], v4 offset:11648
    s_waitcnt lgkmcnt(10)
    v_mfma_f32_32x32x16_bf16 a[48:63], a[108:111], v[76:79], a[48:63]
    ds_read_b64_tr_b16 a[100:101], v4 offset:10432
    ds_read_b64_tr_b16 a[102:103], v4 offset:11712
    s_waitcnt lgkmcnt(10)
    v_mfma_f32_32x32x16_bf16 a[32:47], a[80:83], v[80:83], a[32:47]
    ds_read_b64_tr_b16 a[104:105], v4 offset:15488
    ds_read_b64_tr_b16 a[106:107], v4 offset:16768
    s_waitcnt lgkmcnt(10)
    v_mfma_f32_32x32x16_bf16 a[48:63], a[84:87], v[80:83], a[48:63]
    ds_read_b64_tr_b16 a[108:109], v4 offset:15552
    ds_read_b64_tr_b16 a[110:111], v4 offset:16832
    s_waitcnt lgkmcnt(10)
    v_mfma_f32_32x32x16_bf16 a[32:47], a[88:91], v[84:87], a[32:47]
    ds_read_b64_tr_b16 a[80:81], v5 offset:128
    ds_read_b64_tr_b16 a[82:83], v5 offset:1408
    s_waitcnt lgkmcnt(10)
    v_mfma_f32_32x32x16_bf16 a[48:63], a[92:95], v[84:87], a[48:63]
    ds_read_b64_tr_b16 a[84:85], v5 offset:192
    ds_read_b64_tr_b16 a[86:87], v5 offset:1472
    s_waitcnt lgkmcnt(10)
    v_mfma_f32_32x32x16_bf16 a[32:47], a[96:99], v[88:91], a[32:47]
    ds_read_b64_tr_b16 a[88:89], v5 offset:5248
    ds_read_b64_tr_b16 a[90:91], v5 offset:6528
    s_waitcnt lgkmcnt(10)
    v_mfma_f32_32x32x16_bf16 a[48:63], a[100:103], v[88:91], a[48:63]
    ds_read_b64_tr_b16 a[92:93], v5 offset:5312
    ds_read_b64_tr_b16 a[94:95], v5 offset:6592
    s_waitcnt lgkmcnt(10)
    v_mfma_f32_32x32x16_bf16 a[32:47], a[104:107], v[92:95], a[32:47]
    ds_read_b64_tr_b16 a[96:97], v5 offset:10368
    ds_read_b64_tr_b16 a[98:99], v5 offset:11648
    s_waitcnt lgkmcnt(10)
    v_mfma_f32_32x32x16_bf16 a[48:63], a[108:111], v[92:95], a[48:63]
    ds_read_b64_tr_b16 a[100:101], v5 offset:10432
    ds_read_b64_tr_b16 a[102:103], v5 offset:11712
    s_waitcnt lgkmcnt(10)
    v_mfma_f32_32x32x16_bf16 a[32:47], a[80:83], v[96:99], a[32:47]
    ds_read_b64_tr_b16 a[104:105], v5 offset:15488
    ds_read_b64_tr_b16 a[106:107], v5 offset:16768
    s_waitcnt lgkmcnt(10)
    v_mfma_f32_32x32x16_bf16 a[48:63], a[84:87], v[96:99], a[48:63]
    ds_read_b64_tr_b16 a[108:109], v5 offset:15552
    ds_read_b64_tr_b16 a[110:111], v5 offset:16832
    s_waitcnt lgkmcnt(10)
    v_mfma_f32_32x32x16_bf16 a[32:47], a[88:91], v[100:103], a[32:47]
    ds_read_b64_tr_b16 a[80:81], v6 offset:128
    ds_read_b64_tr_b16 a[82:83], v6 offset:1408
    s_waitcnt lgkmcnt(10)
    v_mfma_f32_32x32x16_bf16 a[48:63], a[92:95], v[100:103], a[48:63]
    ds_read_b64_tr_b16 a[84:85], v6 offset:192
    ds_read_b64_tr_b16 a[86:87], v6 offset:1472
    s_waitcnt lgkmcnt(10)
    v_mfma_f32_32x32x16_bf16 a[32:47], a[96:99], v[104:107], a[32:47]
    ds_read_b64_tr_b16 a[88:89], v6 offset:5248
    ds_read_b64_tr_b16 a[90:91], v6 offset:6528
    s_waitcnt lgkmcnt(10)
    v_mfma_f32_32x32x16_bf16 a[48:63], a[100:103], v[104:107], a[48:63]
    ds_read_b64_tr_b16 a[92:93], v6 offset:5312
    ds_read_b64_tr_b16 a[94:95], v6 offset:6592
    s_waitcnt lgkmcnt(10)
    v_mfma_f32_32x32x16_bf16 a[32:47], a[104:107], v[108:111], a[32:47]
    ds_read_b64_tr_b16 a[96:97], v6 offset:10368
    ds_read_b64_tr_b16 a[98:99], v6 offset:11648
    s_waitcnt lgkmcnt(10)
    v_mfma_f32_32x32x16_bf16 a[48:63], a[108:111], v[108:111], a[48:63]
    ds_read_b64_tr_b16 a[100:101], v6 offset:10432
    ds_read_b64_tr_b16 a[102:103], v6 offset:11712
    s_waitcnt lgkmcnt(10)
    v_mfma_f32_32x32x16_bf16 a[32:47], a[80:83], v[112:115], a[32:47]
    ds_read_b64_tr_b16 a[104:105], v6 offset:15488
    ds_read_b64_tr_b16 a[106:107], v6 offset:16768
    s_waitcnt lgkmcnt(10)
    v_mfma_f32_32x32x16_bf16 a[48:63], a[84:87], v[112:115], a[48:63]
    ds_read_b64_tr_b16 a[108:109], v6 offset:15552
    ds_read_b64_tr_b16 a[110:111], v6 offset:16832
    s_waitcnt lgkmcnt(10)
    v_mfma_f32_32x32x16_bf16 a[32:47], a[88:91], v[116:119], a[32:47]
    ds_read_b64_tr_b16 a[80:81], v7 offset:128
    ds_read_b64_tr_b16 a[82:83], v7 offset:1408
    s_waitcnt lgkmcnt(10)
    v_mfma_f32_32x32x16_bf16 a[48:63], a[92:95], v[116:119], a[48:63]
    ds_read_b64_tr_b16 a[84:85], v7 offset:192
    ds_read_b64_tr_b16 a[86:87], v7 offset:1472
    s_waitcnt lgkmcnt(10)
    v_mfma_f32_32x32x16_bf16 a[32:47], a[96:99], v[120:123], a[32:47]
    ds_read_b64_tr_b16 a[88:89], v7 offset:5248
    ds_read_b64_tr_b16 a[90:91], v7 offset:6528
    s_waitcnt lgkmcnt(10)
    v_mfma_f32_32x32x16_bf16 a[48:63], a[100:103], v[120:123], a[48:63]
    ds_read_b64_tr_b16 a[92:93], v7 offset:5312
    ds_read_b64_tr_b16 a[94:95], v7 offset:6592
    s_waitcnt lgkmcnt(10)
    v_mfma_f32_32x32x16_bf16 a[32:47], a[104:107], v[124:127], a[32:47]
    ds_read_b64_tr_b16 a[96:97], v7 offset:10368
    ds_read_b64_tr_b16 a[98:99], v7 offset:11648
    s_waitcnt lgkmcnt(10)
    v_mfma_f32_32x32x16_bf16 a[48:63], a[108:111], v[124:127], a[48:63]
    ds_read_b64_tr_b16 a[100:101], v7 offset:10432
    ds_read_b64_tr_b16 a[102:103], v7 offset:11712
    s_waitcnt lgkmcnt(10)
    v_mfma_f32_32x32x16_bf16 a[32:47], a[80:83], v[128:131], a[32:47]
    ds_read_b64_tr_b16 a[104:105], v7 offset:15488
    ds_read_b64_tr_b16 a[106:107], v7 offset:16768
    s_waitcnt lgkmcnt(10)
    v_mfma_f32_32x32x16_bf16 a[48:63], a[84:87], v[128:131], a[48:63]
    ds_read_b64_tr_b16 a[108:109], v7 offset:15552
    ds_read_b64_tr_b16 a[110:111], v7 offset:16832
    s_waitcnt lgkmcnt(10)
    v_mfma_f32_32x32x16_bf16 a[32:47], a[88:91], v[132:135], a[32:47]
    ds_read_b64_tr_b16 a[80:81], v2 offset:0
    ds_read_b64_tr_b16 a[82:83], v2 offset:1280
    s_waitcnt lgkmcnt(10)
    v_mfma_f32_32x32x16_bf16 a[48:63], a[92:95], v[132:135], a[48:63]
    ds_read_b64_tr_b16 a[84:85], v2 offset:5120
    ds_read_b64_tr_b16 a[86:87], v2 offset:6400
    s_waitcnt lgkmcnt(10)
    v_mfma_f32_32x32x16_bf16 a[32:47], a[96:99], v[136:139], a[32:47]
    ds_read_b64_tr_b16 a[88:89], v2 offset:10240
    ds_read_b64_tr_b16 a[90:91], v2 offset:11520
    s_waitcnt lgkmcnt(10)
    v_mfma_f32_32x32x16_bf16 a[48:63], a[100:103], v[136:139], a[48:63]
    ds_read_b64_tr_b16 a[92:93], v2 offset:15360
    ds_read_b64_tr_b16 a[94:95], v2 offset:16640
    s_waitcnt lgkmcnt(10)
    v_mfma_f32_32x32x16_bf16 a[32:47], a[104:107], v[140:143], a[32:47]
    ds_read_b64_tr_b16 a[96:97], v3 offset:0
    ds_read_b64_tr_b16 a[98:99], v3 offset:1280
    s_waitcnt lgkmcnt(10)
    v_mfma_f32_32x32x16_bf16 a[48:63], a[108:111], v[140:143], a[48:63]
    ds_read_b64_tr_b16 a[100:101], v3 offset:5120
    ds_read_b64_tr_b16 a[102:103], v3 offset:6400
    s_waitcnt lgkmcnt(10)
    v_mfma_f32_32x32x16_bf16 a[0:15], a[80:83], v[48:51], a[0:15]
    ds_read_b64_tr_b16 a[104:105], v3 offset:10240
    ds_read_b64_tr_b16 a[106:107], v3 offset:11520
    s_waitcnt lgkmcnt(10)
    v_mfma_f32_32x32x16_bf16 a[0:15], a[84:87], v[52:55], a[0:15]
    ds_read_b64_tr_b16 a[108:109], v3 offset:15360
    ds_read_b64_tr_b16 a[110:111], v3 offset:16640
    s_waitcnt lgkmcnt(10)
    v_mfma_f32_32x32x16_bf16 a[0:15], a[88:91], v[56:59], a[0:15]
    ds_read_b64_tr_b16 a[80:81], v4 offset:0
    ds_read_b64_tr_b16 a[82:83], v4 offset:1280
    s_waitcnt lgkmcnt(10)
    v_mfma_f32_32x32x16_bf16 a[0:15], a[92:95], v[60:63], a[0:15]
    ds_read_b64_tr_b16 a[84:85], v4 offset:5120
    ds_read_b64_tr_b16 a[86:87], v4 offset:6400
    s_waitcnt lgkmcnt(10)
    v_mfma_f32_32x32x16_bf16 a[0:15], a[96:99], v[64:67], a[0:15]
    ds_read_b64_tr_b16 a[88:89], v4 offset:10240
    ds_read_b64_tr_b16 a[90:91], v4 offset:11520
    s_waitcnt lgkmcnt(10)
    v_mfma_f32_32x32x16_bf16 a[0:15], a[100:103], v[68:71], a[0:15]
    ds_read_b64_tr_b16 a[92:93], v4 offset:15360
    ds_read_b64_tr_b16 a[94:95], v4 offset:16640
    s_add_u32 s38, s80, 122880
    buffer_store_dwordx4 a[32:35], v42, s[24:27], s38 offen offset:0 sc1
    buffer_store_dwordx4 a[36:39], v42, s[24:27], s38 offen offset:1024 sc1
    s_waitcnt lgkmcnt(10)
    v_mfma_f32_32x32x16_bf16 a[0:15], a[104:107], v[72:75], a[0:15]
    ds_read_b64_tr_b16 a[96:97], v5 offset:0
    ds_read_b64_tr_b16 a[98:99], v5 offset:1280
    buffer_store_dwordx4 a[40:43], v42, s[24:27], s38 offen offset:2048 sc1
    buffer_store_dwordx4 a[44:47], v42, s[24:27], s38 offen offset:3072 sc1
    s_add_u32 s38, s80, 184320
    s_waitcnt lgkmcnt(10)
    v_mfma_f32_32x32x16_bf16 a[0:15], a[108:111], v[76:79], a[0:15]
    ds_read_b64_tr_b16 a[100:101], v5 offset:5120
    ds_read_b64_tr_b16 a[102:103], v5 offset:6400
    buffer_store_dwordx4 a[48:51], v42, s[24:27], s38 offen offset:0 sc1
    buffer_store_dwordx4 a[52:55], v42, s[24:27], s38 offen offset:1024 sc1
    buffer_store_dwordx4 a[56:59], v42, s[24:27], s38 offen offset:2048 sc1
    s_waitcnt lgkmcnt(10)
    v_mfma_f32_32x32x16_bf16 a[0:15], a[80:83], v[80:83], a[0:15]
    ds_read_b64_tr_b16 a[104:105], v5 offset:10240
    ds_read_b64_tr_b16 a[106:107], v5 offset:11520
    buffer_store_dwordx4 a[60:63], v42, s[24:27], s38 offen offset:3072 sc1
    s_waitcnt lgkmcnt(10)
    v_mfma_f32_32x32x16_bf16 a[0:15], a[84:87], v[84:87], a[0:15]
    ds_read_b64_tr_b16 a[108:109], v5 offset:15360
    ds_read_b64_tr_b16 a[110:111], v5 offset:16640
    s_waitcnt lgkmcnt(10)
    v_mfma_f32_32x32x16_bf16 a[0:15], a[88:91], v[88:91], a[0:15]
    ds_read_b64_tr_b16 a[80:81], v6 offset:0
    ds_read_b64_tr_b16 a[82:83], v6 offset:1280
    s_waitcnt lgkmcnt(10)
    v_mfma_f32_32x32x16_bf16 a[0:15], a[92:95], v[92:95], a[0:15]
    ds_read_b64_tr_b16 a[84:85], v6 offset:5120
    ds_read_b64_tr_b16 a[86:87], v6 offset:6400
    s_waitcnt lgkmcnt(10)
    v_mfma_f32_32x32x16_bf16 a[0:15], a[96:99], v[96:99], a[0:15]
    ds_read_b64_tr_b16 a[88:89], v6 offset:10240
    ds_read_b64_tr_b16 a[90:91], v6 offset:11520
    s_waitcnt lgkmcnt(10)
    v_mfma_f32_32x32x16_bf16 a[0:15], a[100:103], v[100:103], a[0:15]
    ds_read_b64_tr_b16 a[92:93], v6 offset:15360
    ds_read_b64_tr_b16 a[94:95], v6 offset:16640
    s_waitcnt lgkmcnt(10)
    v_mfma_f32_32x32x16_bf16 a[0:15], a[104:107], v[104:107], a[0:15]
    ds_read_b64_tr_b16 a[96:97], v7 offset:0
    ds_read_b64_tr_b16 a[98:99], v7 offset:1280
    s_waitcnt lgkmcnt(10)
    v_mfma_f32_32x32x16_bf16 a[0:15], a[108:111], v[108:111], a[0:15]
    ds_read_b64_tr_b16 a[100:101], v7 offset:5120
    ds_read_b64_tr_b16 a[102:103], v7 offset:6400
    s_waitcnt lgkmcnt(10)
    v_mfma_f32_32x32x16_bf16 a[0:15], a[80:83], v[112:115], a[0:15]
    ds_read_b64_tr_b16 a[104:105], v7 offset:10240
    ds_read_b64_tr_b16 a[106:107], v7 offset:11520
    s_waitcnt lgkmcnt(10)
    v_mfma_f32_32x32x16_bf16 a[0:15], a[84:87], v[116:119], a[0:15]
    ds_read_b64_tr_b16 a[108:109], v7 offset:15360
    ds_read_b64_tr_b16 a[110:111], v7 offset:16640
    s_waitcnt lgkmcnt(10)
    v_mfma_f32_32x32x16_bf16 a[0:15], a[88:91], v[120:123], a[0:15]
    s_waitcnt lgkmcnt(8)
    v_mfma_f32_32x32x16_bf16 a[0:15], a[92:95], v[124:127], a[0:15]
    s_waitcnt lgkmcnt(6)
    v_mfma_f32_32x32x16_bf16 a[0:15], a[96:99], v[128:131], a[0:15]
    s_waitcnt lgkmcnt(4)
    v_mfma_f32_32x32x16_bf16 a[0:15], a[100:103], v[132:135], a[0:15]
    s_waitcnt lgkmcnt(2)
    v_mfma_f32_32x32x16_bf16 a[0:15], a[104:107], v[136:139], a[0:15]
    s_waitcnt lgkmcnt(0)
    v_mfma_f32_32x32x16_bf16 a[0:15], a[108:111], v[140:143], a[0:15]
    s_nop 7
    s_nop 7
    v_accvgpr_read_b32 v48, a0
    v_accvgpr_read_b32 v49, a1
    v_accvgpr_read_b32 v50, a2
    v_accvgpr_read_b32 v51, a3
    v_accvgpr_read_b32 v52, a4
    v_accvgpr_read_b32 v53, a5
    v_accvgpr_read_b32 v54, a6
    v_accvgpr_read_b32 v55, a7
    v_accvgpr_read_b32 v56, a8
    v_accvgpr_read_b32 v57, a9
    v_accvgpr_read_b32 v58, a10
    v_accvgpr_read_b32 v59, a11
    v_accvgpr_read_b32 v60, a12
    v_accvgpr_read_b32 v61, a13
    v_accvgpr_read_b32 v62, a14
    v_accvgpr_read_b32 v63, a15
    v_accvgpr_read_b32 v64, a64
    v_accvgpr_read_b32 v65, a65
    v_accvgpr_read_b32 v66, a66
    v_accvgpr_read_b32 v67, a67
    s_branch L_tm_done
L_tm_skip0:
    s_cmp_eq_u32 s33, 1
    s_cbranch_scc0 L_tm_skip1
    ds_read_b64_tr_b16 a[80:81], v2 offset:256
    ds_read_b64_tr_b16 a[82:83], v2 offset:1536
    ds_read_b64_tr_b16 a[84:85], v2 offset:128
    ds_read_b64_tr_b16 a[86:87], v2 offset:1408
    ds_read_b64_tr_b16 a[88:89], v2 offset:5376
    ds_read_b64_tr_b16 a[90:91], v2 offset:6656
    ds_read_b64_tr_b16 a[92:93], v2 offset:5248
    ds_read_b64_tr_b16 a[94:95], v2 offset:6528
    ds_read_b64_tr_b16 a[96:97], v2 offset:10496
    ds_read_b64_tr_b16 a[98:99], v2 offset:11776
    ds_read_b64_tr_b16 a[100:101], v2 offset:10368
    ds_read_b64_tr_b16 a[102:103], v2 offset:11648
    s_waitcnt lgkmcnt(10)
    s_waitcnt vmcnt(16)
    v_mfma_f32_32x32x16_bf16 a[64:79], a[80:83], v[48:51], a[64:79]
    ds_read_b64_tr_b16 a[104:105], v2 offset:15616
    ds_read_b64_tr_b16 a[106:107], v2 offset:16896
    s_waitcnt lgkmcnt(10)
    v_mfma_f32_32x32x16_bf16 a[32:47], a[84:87], v[48:51], a[32:47]
    ds_read_b64_tr_b16 a[108:109], v2 offset:15488
    ds_read_b64_tr_b16 a[110:111], v2 offset:16768
    s_waitcnt lgkmcnt(10)
    v_mfma_f32_32x32x16_bf16 a[64:79], a[88:91], v[52:55], a[64:79]
    ds_read_b64_tr_b16 a[80:81], v3 offset:256
    ds_read_b64_tr_b16 a[82:83], v3 offset:1536
    s_waitcnt lgkmcnt(10)
    v_mfma_f32_32x32x16_bf16 a[32:47], a[92:95], v[52:55], a[32:47]
    ds_read_b64_tr_b16 a[84:85], v3 offset:128
    ds_read_b64_tr_b16 a[86:87], v3 offset:1408
    s_waitcnt lgkmcnt(10)
    v_mfma_f32_32x32x16_bf16 a[64:79], a[96:99], v[56:59], a[64:79]
    ds_read_b64_tr_b16 a[88:89], v3 offset:5376
    ds_read_b64_tr_b16 a[90:91], v3 offset:6656
    s_waitcnt lgkmcnt(10)
    v_mfma_f32_32x32x16_bf16 a[32:47], a[100:103], v[56:59], a[32:47]
    ds_read_b64_tr_b16 a[92:93], v3 offset:5248
    ds_read_b64_tr_b16 a[94:95], v3 offset:6528
    s_waitcnt lgkmcnt(10)
    v_mfma_f32_32x32x16_bf16 a[64:79], a[104:107], v[60:63], a[64:79]
    ds_read_b64_tr_b16 a[96:97], v3 offset:10496
    ds_read_b64_tr_b16 a[98:99], v3 offset:11776
    s_waitcnt lgkmcnt(10)
    v_mfma_f32_32x32x16_bf16 a[32:47], a[108:111], v[60:63], a[32:47]
    ds_read_b64_tr_b16 a[100:101], v3 offset:10368
    ds_read_b64_tr_b16 a[102:103], v3 offset:11648
    s_waitcnt lgkmcnt(10)
    v_mfma_f32_32x32x16_bf16 a[64:79], a[80:83], v[64:67], a[64:79]
    ds_read_b64_tr_b16 a[104:105], v3 offset:15616
    ds_read_b64_tr_b16 a[106:107], v3 offset:16896
    s_waitcnt lgkmcnt(10)
    v_mfma_f32_32x32x16_bf16 a[32:47], a[84:87], v[64:67], a[32:47]
    ds_read_b64_tr_b16 a[108:109], v3 offset:15488
    ds_read_b64_tr_b16 a[110:111], v3 offset:16768
    s_waitcnt lgkmcnt(10)
    v_mfma_f32_32x32x16_bf16 a[64:79], a[88:91], v[68:71], a[64:79]
    ds_read_b64_tr_b16 a[80:81], v4 offset:256
    ds_read_b64_tr_b16 a[82:83], v4 offset:1536
    s_waitcnt lgkmcnt(10)
    v_mfma_f32_32x32x16_bf16 a[32:47], a[92:95], v[68:71], a[32:47]
    ds_read_b64_tr_b16 a[84:85], v4 offset:128
    ds_read_b64_tr_b16 a[86:87], v4 offset:1408
    s_waitcnt lgkmcnt(10)
    v_mfma_f32_32x32x16_bf16 a[64:79], a[96:99], v[72:75], a[64:79]
    ds_read_b64_tr_b16 a[88:89], v4 offset:5376
    ds_read_b64_tr_b16 a[90:91], v4 offset:6656
    s_waitcnt lgkmcnt(10)
    v_mfma_f32_32x32x16_bf16 a[32:47], a[100:103], v[72:75], a[32:47]
    ds_read_b64_tr_b16 a[92:93], v4 offset:5248
    ds_read_b64_tr_b16 a[94:95], v4 offset:6528
    s_waitcnt lgkmcnt(10)
    v_mfma_f32_32x32x16_bf16 a[64:79], a[104:107], v[76:79], a[64:79]
    ds_read_b64_tr_b16 a[96:97], v4 offset:10496
    ds_read_b64_tr_b16 a[98:99], v4 offset:11776
    s_waitcnt lgkmcnt(10)
    v_mfma_f32_32x32x16_bf16 a[32:47], a[108:111], v[76:79], a[32:47]
    ds_read_b64_tr_b16 a[100:101], v4 offset:10368
    ds_read_b64_tr_b16 a[102:103], v4 offset:11648
    s_waitcnt lgkmcnt(10)
    s_waitcnt vmcnt(8)
    v_mfma_f32_32x32x16_bf16 a[64:79], a[80:83], v[80:83], a[64:79]
    ds_read_b64_tr_b16 a[104:105], v4 offset:15616
    ds_read_b64_tr_b16 a[106:107], v4 offset:16896
    s_waitcnt lgkmcnt(10)
    v_mfma_f32_32x32x16_bf16 a[32:47], a[84:87], v[80:83], a[32:47]
    ds_read_b64_tr_b16 a[108:109], v4 offset:15488
    ds_read_b64_tr_b16 a[110:111], v4 offset:16768
    s_waitcnt lgkmcnt(10)
    v_mfma_f32_32x32x16_bf16 a[64:79], a[88:91], v[84:87], a[64:79]
    ds_read_b64_tr_b16 a[80:81], v5 offset:256
    ds_read_b64_tr_b16 a[82:83], v5 offset:1536
    s_waitcnt lgkmcnt(10)
    v_mfma_f32_32x32x16_bf16 a[32:47], a[92:95], v[84:87], a[32:47]
    ds_read_b64_tr_b16 a[84:85], v5 offset:128
    ds_read_b64_tr_b16 a[86:87], v5 offset:1408
    s_waitcnt lgkmcnt(10)
    v_mfma_f32_32x32x16_bf16 a[64:79], a[96:99], v[88:91], a[64:79]
    ds_read_b64_tr_b16 a[88:89], v5 offset:5376
    ds_read_b64_tr_b16 a[90:91], v5 offset:6656
    s_waitcnt lgkmcnt(10)
    v_mfma_f32_32x32x16_bf16 a[32:47], a[100:103], v[88:91], a[32:47]
    ds_read_b64_tr_b16 a[92:93], v5 offset:5248
    ds_read_b64_tr_b16 a[94:95], v5 offset:6528
    s_waitcnt lgkmcnt(10)
    v_mfma_f32_32x32x16_bf16 a[64:79], a[104:107], v[92:95], a[64:79]
    ds_read_b64_tr_b16 a[96:97], v5 offset:10496
    ds_read_b64_tr_b16 a[98:99], v5 offset:11776
    s_waitcnt lgkmcnt(10)
    v_mfma_f32_32x32x16_bf16 a[32:47], a[108:111], v[92:95], a[32:47]
    ds_read_b64_tr_b16 a[100:101], v5 offset:10368
    ds_read_b64_tr_b16 a[102:103], v5 offset:11648
    s_waitcnt lgkmcnt(10)
    v_mfma_f32_32x32x16_bf16 a[64:79], a[80:83], v[96:99], a[64:79]
    ds_read_b64_tr_b16 a[104:105], v5 offset:15616
    ds_read_b64_tr_b16 a[106:107], v5 offset:16896
    s_waitcnt lgkmcnt(10)
    v_mfma_f32_32x32x16_bf16 a[32:47], a[84:87], v[96:99], a[32:47]
    ds_read_b64_tr_b16 a[108:109], v5 offset:15488
    ds_read_b64_tr_b16 a[110:111], v5 offset:16768
    s_waitcnt lgkmcnt(10)
    v_mfma_f32_32x32x16_bf16 a[64:79], a[88:91], v[100:103], a[64:79]
    ds_read_b64_tr_b16 a[80:81], v6 offset:256
    ds_read_b64_tr_b16 a[82:83], v6 offset:1536
    s_waitcnt lgkmcnt(10)
    v_mfma_f32_32x32x16_bf16 a[32:47], a[92:95], v[100:103], a[32:47]
    ds_read_b64_tr_b16 a[84:85], v6 offset:128
    ds_read_b64_tr_b16 a[86:87], v6 offset:1408
    s_waitcnt lgkmcnt(10)
    v_mfma_f32_32x32x16_bf16 a[64:79], a[96:99], v[104:107], a[64:79]
    ds_read_b64_tr_b16 a[88:89], v6 offset:5376
    ds_read_b64_tr_b16 a[90:91], v6 offset:6656
    s_waitcnt lgkmcnt(10)
    v_mfma_f32_32x32x16_bf16 a[32:47], a[100:103], v[104:107], a[32:47]
    ds_read_b64_tr_b16 a[92:93], v6 offset:5248
    ds_read_b64_tr_b16 a[94:95], v6 offset:6528
    s_waitcnt lgkmcnt(10)
    v_mfma_f32_32x32x16_bf16 a[64:79], a[104:107], v[108:111], a[64:79]
    ds_read_b64_tr_b16 a[96:97], v6 offset:10496
    ds_read_b64_tr_b16 a[98:99], v6 offset:11776
    s_waitcnt lgkmcnt(10)
    v_mfma_f32_32x32x16_bf16 a[32:47], a[108:111], v[108:111], a[32:47]
    ds_read_b64_tr_b16 a[100:101], v6 offset:10368
    ds_read_b64_tr_b16 a[102:103], v6 offset:11648
    s_waitcnt lgkmcnt(10)
    s_waitcnt vmcnt(0)
    v_mfma_f32_32x32x16_bf16 a[64:79], a[80:83], v[112:115], a[64:79]
    ds_read_b64_tr_b16 a[104:105], v6 offset:15616
    ds_read_b64_tr_b16 a[106:107], v6 offset:16896
    s_waitcnt lgkmcnt(10)
    v_mfma_f32_32x32x16_bf16 a[32:47], a[84:87], v[112:115], a[32:47]
    ds_read_b64_tr_b16 a[108:109], v6 offset:15488
    ds_read_b64_tr_b16 a[110:111], v6 offset:16768
    s_waitcnt lgkmcnt(10)
    v_mfma_f32_32x32x16_bf16 a[64:79], a[88:91], v[116:119], a[64:79]
    ds_read_b64_tr_b16 a[80:81], v7 offset:256
    ds_read_b64_tr_b16 a[82:83], v7 offset:1536
    s_waitcnt lgkmcnt(10)
    v_mfma_f32_32x32x16_bf16 a[32:47], a[92:95], v[116:119], a[32:47]
    ds_read_b64_tr_b16 a[84:85], v7 offset:128
    ds_read_b64_tr_b16 a[86:87], v7 offset:1408
    s_waitcnt lgkmcnt(10)
    v_mfma_f32_32x32x16_bf16 a[64:79], a[96:99], v[120:123], a[64:79]
    ds_read_b64_tr_b16 a[88:89], v7 offset:5376
    ds_read_b64_tr_b16 a[90:91], v7 offset:6656
    s_waitcnt lgkmcnt(10)
    v_mfma_f32_32x32x16_bf16 a[32:47], a[100:103], v[120:123], a[32:47]
    ds_read_b64_tr_b16 a[92:93], v7 offset:5248
    ds_read_b64_tr_b16 a[94:95], v7 offset:6528
    s_waitcnt lgkmcnt(10)
    v_mfma_f32_32x32x16_bf16 a[64:79], a[104:107], v[124:127], a[64:79]
    ds_read_b64_tr_b16 a[96:97], v7 offset:10496
    ds_read_b64_tr_b16 a[98:99], v7 offset:11776
    s_waitcnt lgkmcnt(10)
    v_mfma_f32_32x32x16_bf16 a[32:47], a[108:111], v[124:127], a[32:47]
    ds_read_b64_tr_b16 a[100:101], v7 offset:10368
    ds_read_b64_tr_b16 a[102:103], v7 offset:11648
    s_waitcnt lgkmcnt(10)
    v_mfma_f32_32x32x16_bf16 a[64:79], a[80:83], v[128:131], a[64:79]
    ds_read_b64_tr_b16 a[104:105], v7 offset:15616
    ds_read_b64_tr_b16 a[106:107], v7 offset:16896
    s_waitcnt lgkmcnt(10)
    v_mfma_f32_32x32x16_bf16 a[32:47], a[84:87], v[128:131], a[32:47]
    ds_read_b64_tr_b16 a[108:109], v7 offset:15488
    ds_read_b64_tr_b16 a[110:111], v7 offset:16768
    s_waitcnt lgkmcnt(10)
    v_mfma_f32_32x32x16_bf16 a[64:79], a[88:91], v[132:135], a[64:79]
    ds_read_b64_tr_b16 a[80:81], v2 offset:192
    ds_read_b64_tr_b16 a[82:83], v2 offset:1472
    s_waitcnt lgkmcnt(10)
    v_mfma_f32_32x32x16_bf16 a[32:47], a[92:95], v[132:135], a[32:47]
    ds_read_b64_tr_b16 a[84:85], v2 offset:0
    ds_read_b64_tr_b16 a[86:87], v2 offset:1280
    s_waitcnt lgkmcnt(10)
    v_mfma_f32_32x32x16_bf16 a[64:79], a[96:99], v[136:139], a[64:79]
    ds_read_b64_tr_b16 a[88:89], v2 offset:5312
    ds_read_b64_tr_b16 a[90:91], v2 offset:6592
    s_waitcnt lgkmcnt(10)
    v_mfma_f32_32x32x16_bf16 a[32:47], a[100:103], v[136:139], a[32:47]
    ds_read_b64_tr_b16 a[92:93], v2 offset:5120
    ds_read_b64_tr_b16 a[94:95], v2 offset:6400
    s_waitcnt lgkmcnt(10)
    v_mfma_f32_32x32x16_bf16 a[64:79], a[104:107], v[140:143], a[64:79]
    ds_read_b64_tr_b16 a[96:97], v2 offset:10432
    ds_read_b64_tr_b16 a[98:99], v2 offset:11712
    s_waitcnt lgkmcnt(10)
    v_mfma_f32_32x32x16_bf16 a[32:47], a[108:111], v[140:143], a[32:47]
    ds_read_b64_tr_b16 a[100:101], v2 offset:10240
    ds_read_b64_tr_b16 a[102:103], v2 offset:11520
    s_waitcnt lgkmcnt(10)
    v_mfma_f32_32x32x16_bf16 a[48:63], a[80:83], v[48:51], a[48:63]
    ds_read_b64_tr_b16 a[104:105], v2 offset:15552
    ds_read_b64_tr_b16 a[106:107], v2 offset:16832
    s_waitcnt lgkmcnt(10)
    v_mfma_f32_32x32x16_bf16 a[0:15], a[84:87], v[48:51], a[0:15]
    ds_read_b64_tr_b16 a[108:109], v2 offset:15360
    ds_read_b64_tr_b16 a[110:111], v2 offset:16640
    s_waitcnt lgkmcnt(10)
    v_mfma_f32_32x32x16_bf16 a[48:63], a[88:91], v[52:55], a[48:63]
    ds_read_b64_tr_b16 a[80:81], v3 offset:192
    ds_read_b64_tr_b16 a[82:83], v3 offset:1472
    s_waitcnt lgkmcnt(10)
    v_mfma_f32_32x32x16_bf16 a[0:15], a[92:95], v[52:55], a[0:15]
    ds_read_b64_tr_b16 a[84:85], v3 offset:0
    ds_read_b64_tr_b16 a[86:87], v3 offset:1280
    s_waitcnt lgkmcnt(10)
    v_mfma_f32_32x32x16_bf16 a[48:63], a[96:99], v[56:59], a[48:63]
    ds_read_b64_tr_b16 a[88:89], v3 offset:5312
    ds_read_b64_tr_b16 a[90:91], v3 offset:6592
    s_waitcnt lgkmcnt(10)
    v_mfma_f32_32x32x16_bf16 a[0:15], a[100:103], v[56:59], a[0:15]
    ds_read_b64_tr_b16 a[92:93], v3 offset:5120
    ds_read_b64_tr_b16 a[94:95], v3 offset:6400
    s_add_u32 s38, s80, 4096
    buffer_store_dwordx4 a[64:67], v42, s[24:27], s38 offen sc1
    s_add_u32 s38, s80, 126976
    s_waitcnt lgkmcnt(10)
    v_mfma_f32_32x32x16_bf16 a[48:63], a[104:107], v[60:63], a[48:63]
    ds_read_b64_tr_b16 a[96:97], v3 offset:10432
    ds_read_b64_tr_b16 a[98:99], v3 offset:11712
    buffer_store_dwordx4 a[72:75], v42, s[24:27], s38 offen sc1
    s_add_u32 s38, s80, 188416
    buffer_store_dwordx4 a[76:79], v42, s[24:27], s38 offen sc1
    s_waitcnt lgkmcnt(10)
    v_mfma_f32_32x32x16_bf16 a[0:15], a[108:111], v[60:63], a[0:15]
    ds_read_b64_tr_b16 a[100:101], v3 offset:10240
    ds_read_b64_tr_b16 a[102:103], v3 offset:11520
    s_add_u32 s38, s80, 122880
    buffer_store_dwordx4 a[32:35], v42, s[24:27], s38 offen offset:0 sc1
    buffer_store_dwordx4 a[36:39], v42, s[24:27], s38 offen offset:1024 sc1
    s_waitcnt lgkmcnt(10)
    v_mfma_f32_32x32x16_bf16 a[48:63], a[80:83], v[64:67], a[48:63]
    ds_read_b64_tr_b16 a[104:105], v3 offset:15552
    ds_read_b64_tr_b16 a[106:107], v3 offset:16832
    buffer_store_dwordx4 a[40:43], v42, s[24:27], s38 offen offset:2048 sc1
    buffer_store_dwordx4 a[44:47], v42, s[24:27], s38 offen offset:3072 sc1
    s_waitcnt lgkmcnt(10)
    v_mfma_f32_32x32x16_bf16 a[0:15], a[84:87], v[64:67], a[0:15]
    ds_read_b64_tr_b16 a[108:109], v3 offset:15360
    ds_read_b64_tr_b16 a[110:111], v3 offset:16640
    s_waitcnt lgkmcnt(10)
    v_mfma_f32_32x32x16_bf16 a[48:63], a[88:91], v[68:71], a[48:63]
    ds_read_b64_tr_b16 a[80:81], v4 offset:192
    ds_read_b64_tr_b16 a[82:83], v4 offset:1472
    s_waitcnt lgkmcnt(10)
    v_mfma_f32_32x32x16_bf16 a[0:15], a[92:95], v[68:71], a[0:15]
    ds_read_b64_tr_b16 a[84:85], v4 offset:0
    ds_read_b64_tr_b16 a[86:87], v4 offset:1280
    s_waitcnt lgkmcnt(10)
    v_mfma_f32_32x32x16_bf16 a[48:63], a[96:99], v[72:75], a[48:63]
    ds_read_b64_tr_b16 a[88:89], v4 offset:5312
    ds_read_b64_tr_b16 a[90:91], v4 offset:6592
    s_waitcnt lgkmcnt(10)
    v_mfma_f32_32x32x16_bf16 a[0:15], a[100:103], v[72:75], a[0:15]
    ds_read_b64_tr_b16 a[92:93], v4 offset:5120
    ds_read_b64_tr_b16 a[94:95], v4 offset:6400
    s_waitcnt lgkmcnt(10)
    v_mfma_f32_32x32x16_bf16 a[48:63], a[104:107], v[76:79], a[48:63]
    ds_read_b64_tr_b16 a[96:97], v4 offset:10432
    ds_read_b64_tr_b16 a[98:99], v4 offset:11712
    s_waitcnt lgkmcnt(10)
    v_mfma_f32_32x32x16_bf16 a[0:15], a[108:111], v[76:79], a[0:15]
    ds_read_b64_tr_b16 a[100:101], v4 offset:10240
    ds_read_b64_tr_b16 a[102:103], v4 offset:11520
    s_waitcnt lgkmcnt(10)
    v_mfma_f32_32x32x16_bf16 a[48:63], a[80:83], v[80:83], a[48:63]
    ds_read_b64_tr_b16 a[104:105], v4 offset:15552
    ds_read_b64_tr_b16 a[106:107], v4 offset:16832
    s_waitcnt lgkmcnt(10)
    v_mfma_f32_32x32x16_bf16 a[0:15], a[84:87], v[80:83], a[0:15]
    ds_read_b64_tr_b16 a[108:109], v4 offset:15360
    ds_read_b64_tr_b16 a[110:111], v4 offset:16640
    s_waitcnt lgkmcnt(10)
    v_mfma_f32_32x32x16_bf16 a[48:63], a[88:91], v[84:87], a[48:63]
    ds_read_b64_tr_b16 a[80:81], v5 offset:192
    ds_read_b64_tr_b16 a[82:83], v5 offset:1472
    s_waitcnt lgkmcnt(10)
    v_mfma_f32_32x32x16_bf16 a[0:15], a[92:95], v[84:87], a[0:15]
    ds_read_b64_tr_b16 a[84:85], v5 offset:0
    ds_read_b64_tr_b16 a[86:87], v5 offset:1280
    s_waitcnt lgkmcnt(10)
    v_mfma_f32_32x32x16_bf16 a[48:63], a[96:99], v[88:91], a[48:63]
    ds_read_b64_tr_b16 a[88:89], v5 offset:5312
    ds_read_b64_tr_b16 a[90:91], v5 offset:6592
    s_waitcnt lgkmcnt(10)
    v_mfma_f32_32x32x16_bf16 a[0:15], a[100:103], v[88:91], a[0:15]
    ds_read_b64_tr_b16 a[92:93], v5 offset:5120
    ds_read_b64_tr_b16 a[94:95], v5 offset:6400
    s_waitcnt lgkmcnt(10)
    v_mfma_f32_32x32x16_bf16 a[48:63], a[104:107], v[92:95], a[48:63]
    ds_read_b64_tr_b16 a[96:97], v5 offset:10432
    ds_read_b64_tr_b16 a[98:99], v5 offset:11712
    s_waitcnt lgkmcnt(10)
    v_mfma_f32_32x32x16_bf16 a[0:15], a[108:111], v[92:95], a[0:15]
    ds_read_b64_tr_b16 a[100:101], v5 offset:10240
    ds_read_b64_tr_b16 a[102:103], v5 offset:11520
    s_waitcnt lgkmcnt(10)
    v_mfma_f32_32x32x16_bf16 a[48:63], a[80:83], v[96:99], a[48:63]
    ds_read_b64_tr_b16 a[104:105], v5 offset:15552
    ds_read_b64_tr_b16 a[106:107], v5 offset:16832
    s_waitcnt lgkmcnt(10)
    v_mfma_f32_32x32x16_bf16 a[0:15], a[84:87], v[96:99], a[0:15]
    ds_read_b64_tr_b16 a[108:109], v5 offset:15360
    ds_read_b64_tr_b16 a[110:111], v5 offset:16640
    s_waitcnt lgkmcnt(10)
    v_mfma_f32_32x32x16_bf16 a[48:63], a[88:91], v[100:103], a[48:63]
    ds_read_b64_tr_b16 a[80:81], v6 offset:192
    ds_read_b64_tr_b16 a[82:83], v6 offset:1472
    s_waitcnt lgkmcnt(10)
    v_mfma_f32_32x32x16_bf16 a[0:15], a[92:95], v[100:103], a[0:15]
    ds_read_b64_tr_b16 a[84:85], v6 offset:0
    ds_read_b64_tr_b16 a[86:87], v6 offset:1280
    s_waitcnt lgkmcnt(10)
    v_mfma_f32_32x32x16_bf16 a[48:63], a[96:99], v[104:107], a[48:63]
    ds_read_b64_tr_b16 a[88:89], v6 offset:5312
    ds_read_b64_tr_b16 a[90:91], v6 offset:6592
    s_waitcnt lgkmcnt(10)
    v_mfma_f32_32x32x16_bf16 a[0:15], a[100:103], v[104:107], a[0:15]
    ds_read_b64_tr_b16 a[92:93], v6 offset:5120
    ds_read_b64_tr_b16 a[94:95], v6 offset:6400
    s_waitcnt lgkmcnt(10)
    v_mfma_f32_32x32x16_bf16 a[48:63], a[104:107], v[108:111], a[48:63]
    ds_read_b64_tr_b16 a[96:97], v6 offset:10432
    ds_read_b64_tr_b16 a[98:99], v6 offset:11712
    s_waitcnt lgkmcnt(10)
    v_mfma_f32_32x32x16_bf16 a[0:15], a[108:111], v[108:111], a[0:15]
    ds_read_b64_tr_b16 a[100:101], v6 offset:10240
    ds_read_b64_tr_b16 a[102:103], v6 offset:11520
    s_waitcnt lgkmcnt(10)
    v_mfma_f32_32x32x16_bf16 a[48:63], a[80:83], v[112:115], a[48:63]
    ds_read_b64_tr_b16 a[104:105], v6 offset:15552
    ds_read_b64_tr_b16 a[106:107], v6 offset:16832
    s_waitcnt lgkmcnt(10)
    v_mfma_f32_32x32x16_bf16 a[0:15], a[84:87], v[112:115], a[0:15]
    ds_read_b64_tr_b16 a[108:109], v6 offset:15360
    ds_read_b64_tr_b16 a[110:111], v6 offset:16640
    s_waitcnt lgkmcnt(10)
    v_mfma_f32_32x32x16_bf16 a[48:63], a[88:91], v[116:119], a[48:63]
    ds_read_b64_tr_b16 a[80:81], v7 offset:192
    ds_read_b64_tr_b16 a[82:83], v7 offset:1472
    s_waitcnt lgkmcnt(10)
    v_mfma_f32_32x32x16_bf16 a[0:15], a[92:95], v[116:119], a[0:15]
    ds_read_b64_tr_b16 a[84:85], v7 offset:0
    ds_read_b64_tr_b16 a[86:87], v7 offset:1280
    s_waitcnt lgkmcnt(10)
    v_mfma_f32_32x32x16_bf16 a[48:63], a[96:99], v[120:123], a[48:63]
    ds_read_b64_tr_b16 a[88:89], v7 offset:5312
    ds_read_b64_tr_b16 a[90:91], v7 offset:6592
    s_waitcnt lgkmcnt(10)
    v_mfma_f32_32x32x16_bf16 a[0:15], a[100:103], v[120:123], a[0:15]
    ds_read_b64_tr_b16 a[92:93], v7 offset:5120
    ds_read_b64_tr_b16 a[94:95], v7 offset:6400
    s_waitcnt lgkmcnt(10)
    v_mfma_f32_32x32x16_bf16 a[48:63], a[104:107], v[124:127], a[48:63]
    ds_read_b64_tr_b16 a[96:97], v7 offset:10432
    ds_read_b64_tr_b16 a[98:99], v7 offset:11712
    s_waitcnt lgkmcnt(10)
    v_mfma_f32_32x32x16_bf16 a[0:15], a[108:111], v[124:127], a[0:15]
    ds_read_b64_tr_b16 a[100:101], v7 offset:10240
    ds_read_b64_tr_b16 a[102:103], v7 offset:11520
    s_waitcnt lgkmcnt(10)
    v_mfma_f32_32x32x16_bf16 a[48:63], a[80:83], v[128:131], a[48:63]
    ds_read_b64_tr_b16 a[104:105], v7 offset:15552
    ds_read_b64_tr_b16 a[106:107], v7 offset:16832
    s_waitcnt lgkmcnt(10)
    v_mfma_f32_32x32x16_bf16 a[0:15], a[84:87], v[128:131], a[0:15]
    ds_read_b64_tr_b16 a[108:109], v7 offset:15360
    ds_read_b64_tr_b16 a[110:111], v7 offset:16640
    s_waitcnt lgkmcnt(10)
    v_mfma_f32_32x32x16_bf16 a[48:63], a[88:91], v[132:135], a[48:63]
    ds_read_b64_tr_b16 a[80:81], v2 offset:64
    ds_read_b64_tr_b16 a[82:83], v2 offset:1344
    s_waitcnt lgkmcnt(10)
    v_mfma_f32_32x32x16_bf16 a[0:15], a[92:95], v[132:135], a[0:15]
    ds_read_b64_tr_b16 a[84:85], v2 offset:5184
    ds_read_b64_tr_b16 a[86:87], v2 offset:6464
    s_waitcnt lgkmcnt(10)
    v_mfma_f32_32x32x16_bf16 a[48:63], a[96:99], v[136:139], a[48:63]
    ds_read_b64_tr_b16 a[88:89], v2 offset:10304
    ds_read_b64_tr_b16 a[90:91], v2 offset:11584
    s_waitcnt lgkmcnt(10)
    v_mfma_f32_32x32x16_bf16 a[0:15], a[100:103], v[136:139], a[0:15]
    ds_read_b64_tr_b16 a[92:93], v2 offset:15424
    ds_read_b64_tr_b16 a[94:95], v2 offset:16704
    s_waitcnt lgkmcnt(10)
    v_mfma_f32_32x32x16_bf16 a[48:63], a[104:107], v[140:143], a[48:63]
    ds_read_b64_tr_b16 a[96:97], v3 offset:64
    ds_read_b64_tr_b16 a[98:99], v3 offset:1344
    s_waitcnt lgkmcnt(10)
    v_mfma_f32_32x32x16_bf16 a[0:15], a[108:111], v[140:143], a[0:15]
    ds_read_b64_tr_b16 a[100:101], v3 offset:5184
    ds_read_b64_tr_b16 a[102:103], v3 offset:6464
    s_waitcnt lgkmcnt(10)
    v_mfma_f32_32x32x16_bf16 a[16:31], a[80:83], v[48:51], a[16:31]
    ds_read_b64_tr_b16 a[104:105], v3 offset:10304
    ds_read_b64_tr_b16 a[106:107], v3 offset:11584
    s_waitcnt lgkmcnt(10)
    v_mfma_f32_32x32x16_bf16 a[16:31], a[84:87], v[52:55], a[16:31]
    ds_read_b64_tr_b16 a[108:109], v3 offset:15424
    ds_read_b64_tr_b16 a[110:111], v3 offset:16704
    s_waitcnt lgkmcnt(10)
    v_mfma_f32_32x32x16_bf16 a[16:31], a[88:91], v[56:59], a[16:31]
    ds_read_b64_tr_b16 a[80:81], v4 offset:64
    ds_read_b64_tr_b16 a[82:83], v4 offset:1344
    s_waitcnt lgkmcnt(10)
    v_mfma_f32_32x32x16_bf16 a[16:31], a[92:95], v[60:63], a[16:31]
    ds_read_b64_tr_b16 a[84:85], v4 offset:5184
    ds_read_b64_tr_b16 a[86:87], v4 offset:6464
    s_waitcnt lgkmcnt(10)
    v_mfma_f32_32x32x16_bf16 a[16:31], a[96:99], v[64:67], a[16:31]
    ds_read_b64_tr_b16 a[88:89], v4 offset:10304
    ds_read_b64_tr_b16 a[90:91], v4 offset:11584
    s_waitcnt lgkmcnt(10)
    v_mfma_f32_32x32x16_bf16 a[16:31], a[100:103], v[68:71], a[16:31]
    ds_read_b64_tr_b16 a[92:93], v4 offset:15424
    ds_read_b64_tr_b16 a[94:95], v4 offset:16704
    s_add_u32 s38, s80, 184320
    buffer_store_dwordx4 a[48:51], v42, s[24:27], s38 offen offset:0 sc1
    buffer_store_dwordx4 a[52:55], v42, s[24:27], s38 offen offset:1024 sc1
    s_waitcnt lgkmcnt(10)
    v_mfma_f32_32x32x16_bf16 a[16:31], a[104:107], v[72:75], a[16:31]
    ds_read_b64_tr_b16 a[96:97], v5 offset:64
    ds_read_b64_tr_b16 a[98:99], v5 offset:1344
    buffer_store_dwordx4 a[56:59], v42, s[24:27], s38 offen offset:2048 sc1
    buffer_store_dwordx4 a[60:63], v42, s[24:27], s38 offen offset:3072 sc1
    s_add_u32 s38, s80, 0
    s_waitcnt lgkmcnt(10)
    v_mfma_f32_32x32x16_bf16 a[16:31], a[108:111], v[76:79], a[16:31]
    ds_read_b64_tr_b16 a[100:101], v5 offset:5184
    ds_read_b64_tr_b16 a[102:103], v5 offset:6464
    buffer_store_dwordx4 a[0:3], v42, s[24:27], s38 offen offset:0 sc1
    buffer_store_dwordx4 a[4:7], v42, s[24:27], s38 offen offset:1024 sc1
    buffer_store_dwordx4 a[8:11], v42, s[24:27], s38 offen offset:2048 sc1
    s_waitcnt lgkmcnt(10)
    v_mfma_f32_32x32x16_bf16 a[16:31], a[80:83], v[80:83], a[16:31]
    ds_read_b64_tr_b16 a[104:105], v5 offset:10304
    ds_read_b64_tr_b16 a[106:107], v5 offset:11584
    buffer_store_dwordx4 a[12:15], v42, s[24:27], s38 offen offset:3072 sc1
    s_waitcnt lgkmcnt(10)
    v_mfma_f32_32x32x16_bf16 a[16:31], a[84:87], v[84:87], a[16:31]
    ds_read_b64_tr_b16 a[108:109], v5 offset:15424
    ds_read_b64_tr_b16 a[110:111], v5 offset:16704
    s_waitcnt lgkmcnt(10)
    v_mfma_f32_32x32x16_bf16 a[16:31], a[88:91], v[88:91], a[16:31]
    ds_read_b64_tr_b16 a[80:81], v6 offset:64
    ds_read_b64_tr_b16 a[82:83], v6 offset:1344
    s_waitcnt lgkmcnt(10)
    v_mfma_f32_32x32x16_bf16 a[16:31], a[92:95], v[92:95], a[16:31]
    ds_read_b64_tr_b16 a[84:85], v6 offset:5184
    ds_read_b64_tr_b16 a[86:87], v6 offset:6464
    s_waitcnt lgkmcnt(10)
    v_mfma_f32_32x32x16_bf16 a[16:31], a[96:99], v[96:99], a[16:31]
    ds_read_b64_tr_b16 a[88:89], v6 offset:10304
    ds_read_b64_tr_b16 a[90:91], v6 offset:11584
    s_waitcnt lgkmcnt(10)
    v_mfma_f32_32x32x16_bf16 a[16:31], a[100:103], v[100:103], a[16:31]
    ds_read_b64_tr_b16 a[92:93], v6 offset:15424
    ds_read_b64_tr_b16 a[94:95], v6 offset:16704
    s_waitcnt lgkmcnt(10)
    v_mfma_f32_32x32x16_bf16 a[16:31], a[104:107], v[104:107], a[16:31]
    ds_read_b64_tr_b16 a[96:97], v7 offset:64
    ds_read_b64_tr_b16 a[98:99], v7 offset:1344
    s_waitcnt lgkmcnt(10)
    v_mfma_f32_32x32x16_bf16 a[16:31], a[108:111], v[108:111], a[16:31]
    ds_read_b64_tr_b16 a[100:101], v7 offset:5184
    ds_read_b64_tr_b16 a[102:103], v7 offset:6464
    s_waitcnt lgkmcnt(10)
    v_mfma_f32_32x32x16_bf16 a[16:31], a[80:83], v[112:115], a[16:31]
    ds_read_b64_tr_b16 a[104:105], v7 offset:10304
    ds_read_b64_tr_b16 a[106:107], v7 offset:11584
    s_waitcnt lgkmcnt(10)
    v_mfma_f32_32x32x16_bf16 a[16:31], a[84:87], v[116:119], a[16:31]
    ds_read_b64_tr_b16 a[108:109], v7 offset:15424
    ds_read_b64_tr_b16 a[110:111], v7 offset:16704
    s_waitcnt lgkmcnt(10)
    v_mfma_f32_32x32x16_bf16 a[16:31], a[88:91], v[120:123], a[16:31]
    s_waitcnt lgkmcnt(8)
    v_mfma_f32_32x32x16_bf16 a[16:31], a[92:95], v[124:127], a[16:31]
    s_waitcnt lgkmcnt(6)
    v_mfma_f32_32x32x16_bf16 a[16:31], a[96:99], v[128:131], a[16:31]
    s_waitcnt lgkmcnt(4)
    v_mfma_f32_32x32x16_bf16 a[16:31], a[100:103], v[132:135], a[16:31]
    s_waitcnt lgkmcnt(2)
    v_mfma_f32_32x32x16_bf16 a[16:31], a[104:107], v[136:139], a[16:31]
    s_waitcnt lgkmcnt(0)
    v_mfma_f32_32x32x16_bf16 a[16:31], a[108:111], v[140:143], a[16:31]
    s_nop 7
    s_nop 7
    v_accvgpr_read_b32 v48, a16
    v_accvgpr_read_b32 v49, a17
    v_accvgpr_read_b32 v50, a18
    v_accvgpr_read_b32 v51, a19
    v_accvgpr_read_b32 v52, a20
    v_accvgpr_read_b32 v53, a21
    v_accvgpr_read_b32 v54, a22
    v_accvgpr_read_b32 v55, a23
    v_accvgpr_read_b32 v56, a24
    v_accvgpr_read_b32 v57, a25
    v_accvgpr_read_b32 v58, a26
    v_accvgpr_read_b32 v59, a27
    v_accvgpr_read_b32 v60, a28
    v_accvgpr_read_b32 v61, a29
    v_accvgpr_read_b32 v62, a30
    v_accvgpr_read_b32 v63, a31
    v_accvgpr_read_b32 v64, a68
    v_accvgpr_read_b32 v65, a69
    v_accvgpr_read_b32 v66, a70
    v_accvgpr_read_b32 v67, a71
    s_branch L_tm_done
L_tm_skip1:
    s_cmp_eq_u32 s33, 2
    s_cbranch_scc0 L_tm_skip2
    ds_read_b64_tr_b16 a[80:81], v2 offset:256
    ds_read_b64_tr_b16 a[82:83], v2 offset:1536
    ds_read_b64_tr_b16 a[84:85], v2 offset:192
    ds_read_b64_tr_b16 a[86:87], v2 offset:1472
    ds_read_b64_tr_b16 a[88:89], v2 offset:5376
    ds_read_b64_tr_b16 a[90:91], v2 offset:6656
    ds_read_b64_tr_b16 a[92:93], v2 offset:5312
    ds_read_b64_tr_b16 a[94:95], v2 offset:6592
    ds_read_b64_tr_b16 a[96:97], v2 offset:10496
    ds_read_b64_tr_b16 a[98:99], v2 offset:11776
    ds_read_b64_tr_b16 a[100:101], v2 offset:10432
    ds_read_b64_tr_b16 a[102:103], v2 offset:11712
    s_waitcnt lgkmcnt(10)
    s_waitcnt vmcnt(16)
    v_mfma_f32_32x32x16_bf16 a[64:79], a[80:83], v[48:51], a[64:79]
    ds_read_b64_tr_b16 a[104:105], v2 offset:15616
    ds_read_b64_tr_b16 a[106:107], v2 offset:16896
    s_waitcnt lgkmcnt(10)
    v_mfma_f32_32x32x16_bf16 a[48:63], a[84:87], v[48:51], a[48:63]
    ds_read_b64_tr_b16 a[108:109], v2 offset:15552
    ds_read_b64_tr_b16 a[110:111], v2 offset:16832
    s_waitcnt lgkmcnt(10)
    v_mfma_f32_32x32x16_bf16 a[64:79], a[88:91], v[52:55], a[64:79]
    ds_read_b64_tr_b16 a[80:81], v3 offset:256
    ds_read_b64_tr_b16 a[82:83], v3 offset:1536
    s_waitcnt lgkmcnt(10)
    v_mfma_f32_32x32x16_bf16 a[48:63], a[92:95], v[52:55], a[48:63]
    ds_read_b64_tr_b16 a[84:85], v3 offset:192
    ds_read_b64_tr_b16 a[86:87], v3 offset:1472
    s_waitcnt lgkmcnt(10)
    v_mfma_f32_32x32x16_bf16 a[64:79], a[96:99], v[56:59], a[64:79]
    ds_read_b64_tr_b16 a[88:89], v3 offset:5376
    ds_read_b64_tr_b16 a[90:91], v3 offset:6656
    s_waitcnt lgkmcnt(10)
    v_mfma_f32_32x32x16_bf16 a[48:63], a[100:103], v[56:59], a[48:63]
    ds_read_b64_tr_b16 a[92:93], v3 offset:5312
    ds_read_b64_tr_b16 a[94:95], v3 offset:6592
    s_waitcnt lgkmcnt(10)
    v_mfma_f32_32x32x16_bf16 a[64:79], a[104:107], v[60:63], a[64:79]
    ds_read_b64_tr_b16 a[96:97], v3 offset:10496
    ds_read_b64_tr_b16 a[98:99], v3 offset:11776
    s_waitcnt lgkmcnt(10)
    v_mfma_f32_32x32x16_bf16 a[48:63], a[108:111], v[60:63], a[48:63]
    ds_read_b64_tr_b16 a[100:101], v3 offset:10432
    ds_read_b64_tr_b16 a[102:103], v3 offset:11712
    s_waitcnt lgkmcnt(10)
    v_mfma_f32_32x32x16_bf16 a[64:79], a[80:83], v[64:67], a[64:79]
    ds_read_b64_tr_b16 a[104:105], v3 offset:15616
    ds_read_b64_tr_b16 a[106:107], v3 offset:16896
    s_waitcnt lgkmcnt(10)
    v_mfma_f32_32x32x16_bf16 a[48:63], a[84:87], v[64:67], a[48:63]
    ds_read_b64_tr_b16 a[108:109], v3 offset:15552
    ds_read_b64_tr_b16 a[110:111], v3 offset:16832
    s_waitcnt lgkmcnt(10)
    v_mfma_f32_32x32x16_bf16 a[64:79], a[88:91], v[68:71], a[64:79]
    ds_read_b64_tr_b16 a[80:81], v4 offset:256
    ds_read_b64_tr_b16 a[82:83], v4 offset:1536
    s_waitcnt lgkmcnt(10)
    v_mfma_f32_32x32x16_bf16 a[48:63], a[92:95], v[68:71], a[48:63]
    ds_read_b64_tr_b16 a[84:85], v4 offset:192
    ds_read_b64_tr_b16 a[86:87], v4 offset:1472
    s_waitcnt lgkmcnt(10)
    v_mfma_f32_32x32x16_bf16 a[64:79], a[96:99], v[72:75], a[64:79]
    ds_read_b64_tr_b16 a[88:89], v4 offset:5376
    ds_read_b64_tr_b16 a[90:91], v4 offset:6656
    s_waitcnt lgkmcnt(10)
    v_mfma_f32_32x32x16_bf16 a[48:63], a[100:103], v[72:75], a[48:63]
    ds_read_b64_tr_b16 a[92:93], v4 offset:5312
    ds_read_b64_tr_b16 a[94:95], v4 offset:6592
    s_waitcnt lgkmcnt(10)
    v_mfma_f32_32x32x16_bf16 a[64:79], a[104:107], v[76:79], a[64:79]
    ds_read_b64_tr_b16 a[96:97], v4 offset:10496
    ds_read_b64_tr_b16 a[98:99], v4 offset:11776
    s_waitcnt lgkmcnt(10)
    v_mfma_f32_32x32x16_bf16 a[48:63], a[108:111], v[76:79], a[48:63]
    ds_read_b64_tr_b16 a[100:101], v4 offset:10432
    ds_read_b64_tr_b16 a[102:103], v4 offset:11712
    s_waitcnt lgkmcnt(10)
    s_waitcnt vmcnt(8)
    v_mfma_f32_32x32x16_bf16 a[64:79], a[80:83], v[80:83], a[64:79]
    ds_read_b64_tr_b16 a[104:105], v4 offset:15616
    ds_read_b64_tr_b16 a[106:107], v4 offset:16896
    s_waitcnt lgkmcnt(10)
    v_mfma_f32_32x32x16_bf16 a[48:63], a[84:87], v[80:83], a[48:63]
    ds_read_b64_tr_b16 a[108:109], v4 offset:15552
    ds_read_b64_tr_b16 a[110:111], v4 offset:16832
    s_waitcnt lgkmcnt(10)
    v_mfma_f32_32x32x16_bf16 a[64:79], a[88:91], v[84:87], a[64:79]
    ds_read_b64_tr_b16 a[80:81], v5 offset:256
    ds_read_b64_tr_b16 a[82:83], v5 offset:1536
    s_waitcnt lgkmcnt(10)
    v_mfma_f32_32x32x16_bf16 a[48:63], a[92:95], v[84:87], a[48:63]
    ds_read_b64_tr_b16 a[84:85], v5 offset:192
    ds_read_b64_tr_b16 a[86:87], v5 offset:1472
    s_waitcnt lgkmcnt(10)
    v_mfma_f32_32x32x16_bf16 a[64:79], a[96:99], v[88:91], a[64:79]
    ds_read_b64_tr_b16 a[88:89], v5 offset:5376
    ds_read_b64_tr_b16 a[90:91], v5 offset:6656
    s_waitcnt lgkmcnt(10)
    v_mfma_f32_32x32x16_bf16 a[48:63], a[100:103], v[88:91], a[48:63]
    ds_read_b64_tr_b16 a[92:93], v5 offset:5312
    ds_read_b64_tr_b16 a[94:95], v5 offset:6592
    s_waitcnt lgkmcnt(10)
    v_mfma_f32_32x32x16_bf16 a[64:79], a[104:107], v[92:95], a[64:79]
    ds_read_b64_tr_b16 a[96:97], v5 offset:10496
    ds_read_b64_tr_b16 a[98:99], v5 offset:11776
    s_waitcnt lgkmcnt(10)
    v_mfma_f32_32x32x16_bf16 a[48:63], a[108:111], v[92:95], a[48:63]
    ds_read_b64_tr_b16 a[100:101], v5 offset:10432
    ds_read_b64_tr_b16 a[102:103], v5 offset:11712
    s_waitcnt lgkmcnt(10)
    v_mfma_f32_32x32x16_bf16 a[64:79], a[80:83], v[96:99], a[64:79]
    ds_read_b64_tr_b16 a[104:105], v5 offset:15616
    ds_read_b64_tr_b16 a[106:107], v5 offset:16896
    s_waitcnt lgkmcnt(10)
    v_mfma_f32_32x32x16_bf16 a[48:63], a[84:87], v[96:99], a[48:63]
    ds_read_b64_tr_b16 a[108:109], v5 offset:15552
    ds_read_b64_tr_b16 a[110:111], v5 offset:16832
    s_waitcnt lgkmcnt(10)
    v_mfma_f32_32x32x16_bf16 a[64:79], a[88:91], v[100:103], a[64:79]
    ds_read_b64_tr_b16 a[80:81], v6 offset:256
    ds_read_b64_tr_b16 a[82:83], v6 offset:1536
    s_waitcnt lgkmcnt(10)
    v_mfma_f32_32x32x16_bf16 a[48:63], a[92:95], v[100:103], a[48:63]
    ds_read_b64_tr_b16 a[84:85], v6 offset:192
    ds_read_b64_tr_b16 a[86:87], v6 offset:1472
    s_waitcnt lgkmcnt(10)
    v_mfma_f32_32x32x16_bf16 a[64:79], a[96:99], v[104:107], a[64:79]
    ds_read_b64_tr_b16 a[88:89], v6 offset:5376
    ds_read_b64_tr_b16 a[90:91], v6 offset:6656
    s_waitcnt lgkmcnt(10)
    v_mfma_f32_32x32x16_bf16 a[48:63], a[100:103], v[104:107], a[48:63]
    ds_read_b64_tr_b16 a[92:93], v6 offset:5312
    ds_read_b64_tr_b16 a[94:95], v6 offset:6592
    s_waitcnt lgkmcnt(10)
    v_mfma_f32_32x32x16_bf16 a[64:79], a[104:107], v[108:111], a[64:79]
    ds_read_b64_tr_b16 a[96:97], v6 offset:10496
    ds_read_b64_tr_b16 a[98:99], v6 offset:11776
    s_waitcnt lgkmcnt(10)
    v_mfma_f32_32x32x16_bf16 a[48:63], a[108:111], v[108:111], a[48:63]
    ds_read_b64_tr_b16 a[100:101], v6 offset:10432
    ds_read_b64_tr_b16 a[102:103], v6 offset:11712
    s_waitcnt lgkmcnt(10)
    s_waitcnt vmcnt(0)
    v_mfma_f32_32x32x16_bf16 a[64:79], a[80:83], v[112:115], a[64:79]
    ds_read_b64_tr_b16 a[104:105], v6 offset:15616
    ds_read_b64_tr_b16 a[106:107], v6 offset:16896
    s_waitcnt lgkmcnt(10)
    v_mfma_f32_32x32x16_bf16 a[48:63], a[84:87], v[112:115], a[48:63]
    ds_read_b64_tr_b16 a[108:109], v6 offset:15552
    ds_read_b64_tr_b16 a[110:111], v6 offset:16832
    s_waitcnt lgkmcnt(10)
    v_mfma_f32_32x32x16_bf16 a[64:79], a[88:91], v[116:119], a[64:79]
    ds_read_b64_tr_b16 a[80:81], v7 offset:256
    ds_read_b64_tr_b16 a[82:83], v7 offset:1536
    s_waitcnt lgkmcnt(10)
    v_mfma_f32_32x32x16_bf16 a[48:63], a[92:95], v[116:119], a[48:63]
    ds_read_b64_tr_b16 a[84:85], v7 offset:192
    ds_read_b64_tr_b16 a[86:87], v7 offset:1472
    s_waitcnt lgkmcnt(10)
    v_mfma_f32_32x32x16_bf16 a[64:79], a[96:99], v[120:123], a[64:79]
    ds_read_b64_tr_b16 a[88:89], v7 offset:5376
    ds_read_b64_tr_b16 a[90:91], v7 offset:6656
    s_waitcnt lgkmcnt(10)
    v_mfma_f32_32x32x16_bf16 a[48:63], a[100:103], v[120:123], a[48:63]
    ds_read_b64_tr_b16 a[92:93], v7 offset:5312
    ds_read_b64_tr_b16 a[94:95], v7 offset:6592
    s_waitcnt lgkmcnt(10)
    v_mfma_f32_32x32x16_bf16 a[64:79], a[104:107], v[124:127], a[64:79]
    ds_read_b64_tr_b16 a[96:97], v7 offset:10496
    ds_read_b64_tr_b16 a[98:99], v7 offset:11776
    s_waitcnt lgkmcnt(10)
    v_mfma_f32_32x32x16_bf16 a[48:63], a[108:111], v[124:127], a[48:63]
    ds_read_b64_tr_b16 a[100:101], v7 offset:10432
    ds_read_b64_tr_b16 a[102:103], v7 offset:11712
    s_waitcnt lgkmcnt(10)
    v_mfma_f32_32x32x16_bf16 a[64:79], a[80:83], v[128:131], a[64:79]
    ds_read_b64_tr_b16 a[104:105], v7 offset:15616
    ds_read_b64_tr_b16 a[106:107], v7 offset:16896
    s_waitcnt lgkmcnt(10)
    v_mfma_f32_32x32x16_bf16 a[48:63], a[84:87], v[128:131], a[48:63]
    ds_read_b64_tr_b16 a[108:109], v7 offset:15552
    ds_read_b64_tr_b16 a[110:111], v7 offset:16832
    s_waitcnt lgkmcnt(10)
    v_mfma_f32_32x32x16_bf16 a[64:79], a[88:91], v[132:135], a[64:79]
    ds_read_b64_tr_b16 a[80:81], v2 offset:0
    ds_read_b64_tr_b16 a[82:83], v2 offset:1280
    s_waitcnt lgkmcnt(10)
    v_mfma_f32_32x32x16_bf16 a[48:63], a[92:95], v[132:135], a[48:63]
    ds_read_b64_tr_b16 a[84:85], v2 offset:64
    ds_read_b64_tr_b16 a[86:87], v2 offset:1344
    s_waitcnt lgkmcnt(10)
    v_mfma_f32_32x32x16_bf16 a[64:79], a[96:99], v[136:139], a[64:79]
    ds_read_b64_tr_b16 a[88:89], v2 offset:5120
    ds_read_b64_tr_b16 a[90:91], v2 offset:6400
    s_waitcnt lgkmcnt(10)
    v_mfma_f32_32x32x16_bf16 a[48:63], a[100:103], v[136:139], a[48:63]
    ds_read_b64_tr_b16 a[92:93], v2 offset:5184
    ds_read_b64_tr_b16 a[94:95], v2 offset:6464
    s_waitcnt lgkmcnt(10)
    v_mfma_f32_32x32x16_bf16 a[64:79], a[104:107], v[140:143], a[64:79]
    ds_read_b64_tr_b16 a[96:97], v2 offset:10240
    ds_read_b64_tr_b16 a[98:99], v2 offset:11520
    s_waitcnt lgkmcnt(10)
    v_mfma_f32_32x32x16_bf16 a[48:63], a[108:111], v[140:143], a[48:63]
    ds_read_b64_tr_b16 a[100:101], v2 offset:10304
    ds_read_b64_tr_b16 a[102:103], v2 offset:11584
    s_waitcnt lgkmcnt(10)
    v_mfma_f32_32x32x16_bf16 a[0:15], a[80:83], v[48:51], a[0:15]
    ds_read_b64_tr_b16 a[104:105], v2 offset:15360
    ds_read_b64_tr_b16 a[106:107], v2 offset:16640
    s_waitcnt lgkmcnt(10)
    v_mfma_f32_32x32x16_bf16 a[16:31], a[84:87], v[48:51], a[16:31]
    ds_read_b64_tr_b16 a[108:109], v2 offset:15424
    ds_read_b64_tr_b16 a[110:111], v2 offset:16704
    s_waitcnt lgkmcnt(10)
    v_mfma_f32_32x32x16_bf16 a[0:15], a[88:91], v[52:55], a[0:15]
    ds_read_b64_tr_b16 a[80:81], v3 offset:0
    ds_read_b64_tr_b16 a[82:83], v3 offset:1280
    s_waitcnt lgkmcnt(10)
    v_mfma_f32_32x32x16_bf16 a[16:31], a[92:95], v[52:55], a[16:31]
    ds_read_b64_tr_b16 a[84:85], v3 offset:64
    ds_read_b64_tr_b16 a[86:87], v3 offset:1344
    s_waitcnt lgkmcnt(10)
    v_mfma_f32_32x32x16_bf16 a[0:15], a[96:99], v[56:59], a[0:15]
    ds_read_b64_tr_b16 a[88:89], v3 offset:5120
    ds_read_b64_tr_b16 a[90:91], v3 offset:6400
    s_waitcnt lgkmcnt(10)
    v_mfma_f32_32x32x16_bf16 a[16:31], a[100:103], v[56:59], a[16:31]
    ds_read_b64_tr_b16 a[92:93], v3 offset:5184
    ds_read_b64_tr_b16 a[94:95], v3 offset:6464
    s_add_u32 s38, s80, 4096
    buffer_store_dwordx4 a[64:67], v42, s[24:27], s38 offen sc1
    s_add_u32 s38, s80, 65536
    s_waitcnt lgkmcnt(10)
    v_mfma_f32_32x32x16_bf16 a[0:15], a[104:107], v[60:63], a[0:15]
    ds_read_b64_tr_b16 a[96:97], v3 offset:10240
    ds_read_b64_tr_b16 a[98:99], v3 offset:11520
    buffer_store_dwordx4 a[68:71], v42, s[24:27], s38 offen sc1
    s_add_u32 s38, s80, 188416
    buffer_store_dwordx4 a[76:79], v42, s[24:27], s38 offen sc1
    s_waitcnt lgkmcnt(10)
    v_mfma_f32_32x32x16_bf16 a[16:31], a[108:111], v[60:63], a[16:31]
    ds_read_b64_tr_b16 a[100:101], v3 offset:10304
    ds_read_b64_tr_b16 a[102:103], v3 offset:11584
    s_add_u32 s38, s80, 184320
    buffer_store_dwordx4 a[48:51], v42, s[24:27], s38 offen offset:0 sc1
    buffer_store_dwordx4 a[52:55], v42, s[24:27], s38 offen offset:1024 sc1
    s_waitcnt lgkmcnt(10)
    v_mfma_f32_32x32x16_bf16 a[0:15], a[80:83], v[64:67], a[0:15]
    ds_read_b64_tr_b16 a[104:105], v3 offset:15360
    ds_read_b64_tr_b16 a[106:107], v3 offset:16640
    buffer_store_dwordx4 a[56:59], v42, s[24:27], s38 offen offset:2048 sc1
    buffer_store_dwordx4 a[60:63], v42, s[24:27], s38 offen offset:3072 sc1
    s_waitcnt lgkmcnt(10)
    v_mfma_f32_32x32x16_bf16 a[16:31], a[84:87], v[64:67], a[16:31]
    ds_read_b64_tr_b16 a[108:109], v3 offset:15424
    ds_read_b64_tr_b16 a[110:111], v3 offset:16704
    s_waitcnt lgkmcnt(10)
    v_mfma_f32_32x32x16_bf16 a[0:15], a[88:91], v[68:71], a[0:15]
    ds_read_b64_tr_b16 a[80:81], v4 offset:0
    ds_read_b64_tr_b16 a[82:83], v4 offset:1280
    s_waitcnt lgkmcnt(10)
    v_mfma_f32_32x32x16_bf16 a[16:31], a[92:95], v[68:71], a[16:31]
    ds_read_b64_tr_b16 a[84:85], v4 offset:64
    ds_read_b64_tr_b16 a[86:87], v4 offset:1344
    s_waitcnt lgkmcnt(10)
    v_mfma_f32_32x32x16_bf16 a[0:15], a[96:99], v[72:75], a[0:15]
    ds_read_b64_tr_b16 a[88:89], v4 offset:5120
    ds_read_b64_tr_b16 a[90:91], v4 offset:6400
    s_waitcnt lgkmcnt(10)
    v_mfma_f32_32x32x16_bf16 a[16:31], a[100:103], v[72:75], a[16:31]
    ds_read_b64_tr_b16 a[92:93], v4 offset:5184
    ds_read_b64_tr_b16 a[94:95], v4 offset:6464
    s_waitcnt lgkmcnt(10)
    v_mfma_f32_32x32x16_bf16 a[0:15], a[104:107], v[76:79], a[0:15]
    ds_read_b64_tr_b16 a[96:97], v4 offset:10240
    ds_read_b64_tr_b16 a[98:99], v4 offset:11520
    s_waitcnt lgkmcnt(10)
    v_mfma_f32_32x32x16_bf16 a[16:31], a[108:111], v[76:79], a[16:31]
    ds_read_b64_tr_b16 a[100:101], v4 offset:10304
    ds_read_b64_tr_b16 a[102:103], v4 offset:11584
    s_waitcnt lgkmcnt(10)
    v_mfma_f32_32x32x16_bf16 a[0:15], a[80:83], v[80:83], a[0:15]
    ds_read_b64_tr_b16 a[104:105], v4 offset:15360
    ds_read_b64_tr_b16 a[106:107], v4 offset:16640
    s_waitcnt lgkmcnt(10)
    v_mfma_f32_32x32x16_bf16 a[16:31], a[84:87], v[80:83], a[16:31]
    ds_read_b64_tr_b16 a[108:109], v4 offset:15424
    ds_read_b64_tr_b16 a[110:111], v4 offset:16704
    s_waitcnt lgkmcnt(10)
    v_mfma_f32_32x32x16_bf16 a[0:15], a[88:91], v[84:87], a[0:15]
    ds_read_b64_tr_b16 a[80:81], v5 offset:0
    ds_read_b64_tr_b16 a[82:83], v5 offset:1280
    s_waitcnt lgkmcnt(10)
    v_mfma_f32_32x32x16_bf16 a[16:31], a[92:95], v[84:87], a[16:31]
    ds_read_b64_tr_b16 a[84:85], v5 offset:64
    ds_read_b64_tr_b16 a[86:87], v5 offset:1344
    s_waitcnt lgkmcnt(10)
    v_mfma_f32_32x32x16_bf16 a[0:15], a[96:99], v[88:91], a[0:15]
    ds_read_b64_tr_b16 a[88:89], v5 offset:5120
    ds_read_b64_tr_b16 a[90:91], v5 offset:6400
    s_waitcnt lgkmcnt(10)
    v_mfma_f32_32x32x16_bf16 a[16:31], a[100:103], v[88:91], a[16:31]
    ds_read_b64_tr_b16 a[92:93], v5 offset:5184
    ds_read_b64_tr_b16 a[94:95], v5 offset:6464
    s_waitcnt lgkmcnt(10)
    v_mfma_f32_32x32x16_bf16 a[0:15], a[104:107], v[92:95], a[0:15]
    ds_read_b64_tr_b16 a[96:97], v5 offset:10240
    ds_read_b64_tr_b16 a[98:99], v5 offset:11520
    s_waitcnt lgkmcnt(10)
    v_mfma_f32_32x32x16_bf16 a[16:31], a[108:111], v[92:95], a[16:31]
    ds_read_b64_tr_b16 a[100:101], v5 offset:10304
    ds_read_b64_tr_b16 a[102:103], v5 offset:11584
    s_waitcnt lgkmcnt(10)
    v_mfma_f32_32x32x16_bf16 a[0:15], a[80:83], v[96:99], a[0:15]
    ds_read_b64_tr_b16 a[104:105], v5 offset:15360
    ds_read_b64_tr_b16 a[106:107], v5 offset:16640
    s_waitcnt lgkmcnt(10)
    v_mfma_f32_32x32x16_bf16 a[16:31], a[84:87], v[96:99], a[16:31]
    ds_read_b64_tr_b16 a[108:109], v5 offset:15424
    ds_read_b64_tr_b16 a[110:111], v5 offset:16704
    s_waitcnt lgkmcnt(10)
    v_mfma_f32_32x32x16_bf16 a[0:15], a[88:91], v[100:103], a[0:15]
    ds_read_b64_tr_b16 a[80:81], v6 offset:0
    ds_read_b64_tr_b16 a[82:83], v6 offset:1280
    s_waitcnt lgkmcnt(10)
    v_mfma_f32_32x32x16_bf16 a[16:31], a[92:95], v[100:103], a[16:31]
    ds_read_b64_tr_b16 a[84:85], v6 offset:64
    ds_read_b64_tr_b16 a[86:87], v6 offset:1344
    s_waitcnt lgkmcnt(10)
    v_mfma_f32_32x32x16_bf16 a[0:15], a[96:99], v[104:107], a[0:15]
    ds_read_b64_tr_b16 a[88:89], v6 offset:5120
    ds_read_b64_tr_b16 a[90:91], v6 offset:6400
    s_waitcnt lgkmcnt(10)
    v_mfma_f32_32x32x16_bf16 a[16:31], a[100:103], v[104:107], a[16:31]
    ds_read_b64_tr_b16 a[92:93], v6 offset:5184
    ds_read_b64_tr_b16 a[94:95], v6 offset:6464
    s_waitcnt lgkmcnt(10)
    v_mfma_f32_32x32x16_bf16 a[0:15], a[104:107], v[108:111], a[0:15]
    ds_read_b64_tr_b16 a[96:97], v6 offset:10240
    ds_read_b64_tr_b16 a[98:99], v6 offset:11520
    s_waitcnt lgkmcnt(10)
    v_mfma_f32_32x32x16_bf16 a[16:31], a[108:111], v[108:111], a[16:31]
    ds_read_b64_tr_b16 a[100:101], v6 offset:10304
    ds_read_b64_tr_b16 a[102:103], v6 offset:11584
    s_waitcnt lgkmcnt(10)
    v_mfma_f32_32x32x16_bf16 a[0:15], a[80:83], v[112:115], a[0:15]
    ds_read_b64_tr_b16 a[104:105], v6 offset:15360
    ds_read_b64_tr_b16 a[106:107], v6 offset:16640
    s_waitcnt lgkmcnt(10)
    v_mfma_f32_32x32x16_bf16 a[16:31], a[84:87], v[112:115], a[16:31]
    ds_read_b64_tr_b16 a[108:109], v6 offset:15424
    ds_read_b64_tr_b16 a[110:111], v6 offset:16704
    s_waitcnt lgkmcnt(10)
    v_mfma_f32_32x32x16_bf16 a[0:15], a[88:91], v[116:119], a[0:15]
    ds_read_b64_tr_b16 a[80:81], v7 offset:0
    ds_read_b64_tr_b16 a[82:83], v7 offset:1280
    s_waitcnt lgkmcnt(10)
    v_mfma_f32_32x32x16_bf16 a[16:31], a[92:95], v[116:119], a[16:31]
    ds_read_b64_tr_b16 a[84:85], v7 offset:64
    ds_read_b64_tr_b16 a[86:87], v7 offset:1344
    s_waitcnt lgkmcnt(10)
    v_mfma_f32_32x32x16_bf16 a[0:15], a[96:99], v[120:123], a[0:15]
    ds_read_b64_tr_b16 a[88:89], v7 offset:5120
    ds_read_b64_tr_b16 a[90:91], v7 offset:6400
    s_waitcnt lgkmcnt(10)
    v_mfma_f32_32x32x16_bf16 a[16:31], a[100:103], v[120:123], a[16:31]
    ds_read_b64_tr_b16 a[92:93], v7 offset:5184
    ds_read_b64_tr_b16 a[94:95], v7 offset:6464
    s_waitcnt lgkmcnt(10)
    v_mfma_f32_32x32x16_bf16 a[0:15], a[104:107], v[124:127], a[0:15]
    ds_read_b64_tr_b16 a[96:97], v7 offset:10240
    ds_read_b64_tr_b16 a[98:99], v7 offset:11520
    s_waitcnt lgkmcnt(10)
    v_mfma_f32_32x32x16_bf16 a[16:31], a[108:111], v[124:127], a[16:31]
    ds_read_b64_tr_b16 a[100:101], v7 offset:10304
    ds_read_b64_tr_b16 a[102:103], v7 offset:11584
    s_waitcnt lgkmcnt(10)
    v_mfma_f32_32x32x16_bf16 a[0:15], a[80:83], v[128:131], a[0:15]
    ds_read_b64_tr_b16 a[104:105], v7 offset:15360
    ds_read_b64_tr_b16 a[106:107], v7 offset:16640
    s_waitcnt lgkmcnt(10)
    v_mfma_f32_32x32x16_bf16 a[16:31], a[84:87], v[128:131], a[16:31]
    ds_read_b64_tr_b16 a[108:109], v7 offset:15424
    ds_read_b64_tr_b16 a[110:111], v7 offset:16704
    s_waitcnt lgkmcnt(10)
    v_mfma_f32_32x32x16_bf16 a[0:15], a[88:91], v[132:135], a[0:15]
    ds_read_b64_tr_b16 a[80:81], v2 offset:128
    ds_read_b64_tr_b16 a[82:83], v2 offset:1408
    s_waitcnt lgkmcnt(10)
    v_mfma_f32_32x32x16_bf16 a[16:31], a[92:95], v[132:135], a[16:31]
    ds_read_b64_tr_b16 a[84:85], v2 offset:5248
    ds_read_b64_tr_b16 a[86:87], v2 offset:6528
    s_waitcnt lgkmcnt(10)
    v_mfma_f32_32x32x16_bf16 a[0:15], a[96:99], v[136:139], a[0:15]
    ds_read_b64_tr_b16 a[88:89], v2 offset:10368
    ds_read_b64_tr_b16 a[90:91], v2 offset:11648
    s_waitcnt lgkmcnt(10)
    v_mfma_f32_32x32x16_bf16 a[16:31], a[100:103], v[136:139], a[16:31]
    ds_read_b64_tr_b16 a[92:93], v2 offset:15488
    ds_read_b64_tr_b16 a[94:95], v2 offset:16768
    s_waitcnt lgkmcnt(10)
    v_mfma_f32_32x32x16_bf16 a[0:15], a[104:107], v[140:143], a[0:15]
    ds_read_b64_tr_b16 a[96:97], v3 offset:128
    ds_read_b64_tr_b16 a[98:99], v3 offset:1408
    s_waitcnt lgkmcnt(10)
    v_mfma_f32_32x32x16_bf16 a[16:31], a[108:111], v[140:143], a[16:31]
    ds_read_b64_tr_b16 a[100:101], v3 offset:5248
    ds_read_b64_tr_b16 a[102:103], v3 offset:6528
    s_waitcnt lgkmcnt(10)
    v_mfma_f32_32x32x16_bf16 a[32:47], a[80:83], v[48:51], a[32:47]
    ds_read_b64_tr_b16 a[104:105], v3 offset:10368
    ds_read_b64_tr_b16 a[106:107], v3 offset:11648
    s_waitcnt lgkmcnt(10)
    v_mfma_f32_32x32x16_bf16 a[32:47], a[84:87], v[52:55], a[32:47]
    ds_read_b64_tr_b16 a[108:109], v3 offset:15488
    ds_read_b64_tr_b16 a[110:111], v3 offset:16768
    s_waitcnt lgkmcnt(10)
    v_mfma_f32_32x32x16_bf16 a[32:47], a[88:91], v[56:59], a[32:47]
    ds_read_b64_tr_b16 a[80:81], v4 offset:128
    ds_read_b64_tr_b16 a[82:83], v4 offset:1408
    s_waitcnt lgkmcnt(10)
    v_mfma_f32_32x32x16_bf16 a[32:47], a[92:95], v[60:63], a[32:47]
    ds_read_b64_tr_b16 a[84:85], v4 offset:5248
    ds_read_b64_tr_b16 a[86:87], v4 offset:6528
    s_waitcnt lgkmcnt(10)
    v_mfma_f32_32x32x16_bf16 a[32:47], a[96:99], v[64:67], a[32:47]
    ds_read_b64_tr_b16 a[88:89], v4 offset:10368
    ds_read_b64_tr_b16 a[90:91], v4 offset:11648
    s_waitcnt lgkmcnt(10)
    v_mfma_f32_32x32x16_bf16 a[32:47], a[100:103], v[68:71], a[32:47]
    ds_read_b64_tr_b16 a[92:93], v4 offset:15488
    ds_read_b64_tr_b16 a[94:95], v4 offset:16768
    s_add_u32 s38, s80, 0
    buffer_store_dwordx4 a[0:3], v42, s[24:27], s38 offen offset:0 sc1
    buffer_store_dwordx4 a[4:7], v42, s[24:27], s38 offen offset:1024 sc1
    s_waitcnt lgkmcnt(10)
    v_mfma_f32_32x32x16_bf16 a[32:47], a[104:107], v[72:75], a[32:47]
    ds_read_b64_tr_b16 a[96:97], v5 offset:128
    ds_read_b64_tr_b16 a[98:99], v5 offset:1408
    buffer_store_dwordx4 a[8:11], v42, s[24:27], s38 offen offset:2048 sc1
    buffer_store_dwordx4 a[12:15], v42, s[24:27], s38 offen offset:3072 sc1
    s_add_u32 s38, s80, 61440
    s_waitcnt lgkmcnt(10)
    v_mfma_f32_32x32x16_bf16 a[32:47], a[108:111], v[76:79], a[32:47]
    ds_read_b64_tr_b16 a[100:101], v5 offset:5248
    ds_read_b64_tr_b16 a[102:103], v5 offset:6528
    buffer_store_dwordx4 a[16:19], v42, s[24:27], s38 offen offset:0 sc1
    buffer_store_dwordx4 a[20:23], v42, s[24:27], s38 offen offset:1024 sc1
    buffer_store_dwordx4 a[24:27], v42, s[24:27], s38 offen offset:2048 sc1
    s_waitcnt lgkmcnt(10)
    v_mfma_f32_32x32x16_bf16 a[32:47], a[80:83], v[80:83], a[32:47]
    ds_read_b64_tr_b16 a[104:105], v5 offset:10368
    ds_read_b64_tr_b16 a[106:107], v5 offset:11648
    buffer_store_dwordx4 a[28:31], v42, s[24:27], s38 offen offset:3072 sc1
    s_waitcnt lgkmcnt(10)
    v_mfma_f32_32x32x16_bf16 a[32:47], a[84:87], v[84:87], a[32:47]
    ds_read_b64_tr_b16 a[108:109], v5 offset:15488
    ds_read_b64_tr_b16 a[110:111], v5 offset:16768
    s_waitcnt lgkmcnt(10)
    v_mfma_f32_32x32x16_bf16 a[32:47], a[88:91], v[88:91], a[32:47]
    ds_read_b64_tr_b16 a[80:81], v6 offset:128
    ds_read_b64_tr_b16 a[82:83], v6 offset:1408
    s_waitcnt lgkmcnt(10)
    v_mfma_f32_32x32x16_bf16 a[32:47], a[92:95], v[92:95], a[32:47]
    ds_read_b64_tr_b16 a[84:85], v6 offset:5248
    ds_read_b64_tr_b16 a[86:87], v6 offset:6528
    s_waitcnt lgkmcnt(10)
    v_mfma_f32_32x32x16_bf16 a[32:47], a[96:99], v[96:99], a[32:47]
    ds_read_b64_tr_b16 a[88:89], v6 offset:10368
    ds_read_b64_tr_b16 a[90:91], v6 offset:11648
    s_waitcnt lgkmcnt(10)
    v_mfma_f32_32x32x16_bf16 a[32:47], a[100:103], v[100:103], a[32:47]
    ds_read_b64_tr_b16 a[92:93], v6 offset:15488
    ds_read_b64_tr_b16 a[94:95], v6 offset:16768
    s_waitcnt lgkmcnt(10)
    v_mfma_f32_32x32x16_bf16 a[32:47], a[104:107], v[104:107], a[32:47]
    ds_read_b64_tr_b16 a[96:97], v7 offset:128
    ds_read_b64_tr_b16 a[98:99], v7 offset:1408
    s_waitcnt lgkmcnt(10)
    v_mfma_f32_32x32x16_bf16 a[32:47], a[108:111], v[108:111], a[32:47]
    ds_read_b64_tr_b16 a[100:101], v7 offset:5248
    ds_read_b64_tr_b16 a[102:103], v7 offset:6528
    s_waitcnt lgkmcnt(10)
    v_mfma_f32_32x32x16_bf16 a[32:47], a[80:83], v[112:115], a[32:47]
    ds_read_b64_tr_b16 a[104:105], v7 offset:10368
    ds_read_b64_tr_b16 a[106:107], v7 offset:11648
    s_waitcnt lgkmcnt(10)
    v_mfma_f32_32x32x16_bf16 a[32:47], a[84:87], v[116:119], a[32:47]
    ds_read_b64_tr_b16 a[108:109], v7 offset:15488
    ds_read_b64_tr_b16 a[110:111], v7 offset:16768
    s_waitcnt lgkmcnt(10)
    v_mfma_f32_32x32x16_bf16 a[32:47], a[88:91], v[120:123], a[32:47]
    s_waitcnt lgkmcnt(8)
    v_mfma_f32_32x32x16_bf16 a[32:47], a[92:95], v[124:127], a[32:47]
    s_waitcnt lgkmcnt(6)
    v_mfma_f32_32x32x16_bf16 a[32:47], a[96:99], v[128:131], a[32:47]
    s_waitcnt lgkmcnt(4)
    v_mfma_f32_32x32x16_bf16 a[32:47], a[100:103], v[132:135], a[32:47]
    s_waitcnt lgkmcnt(2)
    v_mfma_f32_32x32x16_bf16 a[32:47], a[104:107], v[136:139], a[32:47]
    s_waitcnt lgkmcnt(0)
    v_mfma_f32_32x32x16_bf16 a[32:47], a[108:111], v[140:143], a[32:47]
    s_nop 7
    s_nop 7
    v_accvgpr_read_b32 v48, a32
    v_accvgpr_read_b32 v49, a33
    v_accvgpr_read_b32 v50, a34
    v_accvgpr_read_b32 v51, a35
    v_accvgpr_read_b32 v52, a36
    v_accvgpr_read_b32 v53, a37
    v_accvgpr_read_b32 v54, a38
    v_accvgpr_read_b32 v55, a39
    v_accvgpr_read_b32 v56, a40
    v_accvgpr_read_b32 v57, a41
    v_accvgpr_read_b32 v58, a42
    v_accvgpr_read_b32 v59, a43
    v_accvgpr_read_b32 v60, a44
    v_accvgpr_read_b32 v61, a45
    v_accvgpr_read_b32 v62, a46
    v_accvgpr_read_b32 v63, a47
    v_accvgpr_read_b32 v64, a72
    v_accvgpr_read_b32 v65, a73
    v_accvgpr_read_b32 v66, a74
    v_accvgpr_read_b32 v67, a75
    s_branch L_tm_done
L_tm_skip2:
    s_cmp_eq_u32 s33, 3
    s_cbranch_scc0 L_tm_skip3
    ds_read_b64_tr_b16 a[80:81], v2 offset:256
    ds_read_b64_tr_b16 a[82:83], v2 offset:1536
    ds_read_b64_tr_b16 a[84:85], v2 offset:0
    ds_read_b64_tr_b16 a[86:87], v2 offset:1280
    ds_read_b64_tr_b16 a[88:89], v2 offset:5376
    ds_read_b64_tr_b16 a[90:91], v2 offset:6656
    ds_read_b64_tr_b16 a[92:93], v2 offset:5120
    ds_read_b64_tr_b16 a[94:95], v2 offset:6400
    ds_read_b64_tr_b16 a[96:97], v2 offset:10496
    ds_read_b64_tr_b16 a[98:99], v2 offset:11776
    ds_read_b64_tr_b16 a[100:101], v2 offset:10240
    ds_read_b64_tr_b16 a[102:103], v2 offset:11520
    s_waitcnt lgkmcnt(10)
    s_waitcnt vmcnt(16)
    v_mfma_f32_32x32x16_bf16 a[64:79], a[80:83], v[48:51], a[64:79]
    ds_read_b64_tr_b16 a[104:105], v2 offset:15616
    ds_read_b64_tr_b16 a[106:107], v2 offset:16896
    s_waitcnt lgkmcnt(10)
    v_mfma_f32_32x32x16_bf16 a[0:15], a[84:87], v[48:51], a[0:15]
    ds_read_b64_tr_b16 a[108:109], v2 offset:15360
    ds_read_b64_tr_b16 a[110:111], v2 offset:16640
    s_waitcnt lgkmcnt(10)
    v_mfma_f32_32x32x16_bf16 a[64:79], a[88:91], v[52:55], a[64:79]
    ds_read_b64_tr_b16 a[80:81], v3 offset:256
    ds_read_b64_tr_b16 a[82:83], v3 offset:1536
    s_waitcnt lgkmcnt(10)
    v_mfma_f32_32x32x16_bf16 a[0:15], a[92:95], v[52:55], a[0:15]
    ds_read_b64_tr_b16 a[84:85], v3 offset:0
    ds_read_b64_tr_b16 a[86:87], v3 offset:1280
    s_waitcnt lgkmcnt(10)
    v_mfma_f32_32x32x16_bf16 a[64:79], a[96:99], v[56:59], a[64:79]
    ds_read_b64_tr_b16 a[88:89], v3 offset:5376
    ds_read_b64_tr_b16 a[90:91], v3 offset:6656
    s_waitcnt lgkmcnt(10)
    v_mfma_f32_32x32x16_bf16 a[0:15], a[100:103], v[56:59], a[0:15]
    ds_read_b64_tr_b16 a[92:93], v3 offset:5120
    ds_read_b64_tr_b16 a[94:95], v3 offset:6400
    s_waitcnt lgkmcnt(10)
    v_mfma_f32_32x32x16_bf16 a[64:79], a[104:107], v[60:63], a[64:79]
    ds_read_b64_tr_b16 a[96:97], v3 offset:10496
    ds_read_b64_tr_b16 a[98:99], v3 offset:11776
    s_waitcnt lgkmcnt(10)
    v_mfma_f32_32x32x16_bf16 a[0:15], a[108:111], v[60:63], a[0:15]
    ds_read_b64_tr_b16 a[100:101], v3 offset:10240
    ds_read_b64_tr_b16 a[102:103], v3 offset:11520
    s_waitcnt lgkmcnt(10)
    v_mfma_f32_32x32x16_bf16 a[64:79], a[80:83], v[64:67], a[64:79]
    ds_read_b64_tr_b16 a[104:105], v3 offset:15616
    ds_read_b64_tr_b16 a[106:107], v3 offset:16896
    s_waitcnt lgkmcnt(10)
    v_mfma_f32_32x32x16_bf16 a[0:15], a[84:87], v[64:67], a[0:15]
    ds_read_b64_tr_b16 a[108:109], v3 offset:15360
    ds_read_b64_tr_b16 a[110:111], v3 offset:16640
    s_waitcnt lgkmcnt(10)
    v_mfma_f32_32x32x16_bf16 a[64:79], a[88:91], v[68:71], a[64:79]
    ds_read_b64_tr_b16 a[80:81], v4 offset:256
    ds_read_b64_tr_b16 a[82:83], v4 offset:1536
    s_waitcnt lgkmcnt(10)
    v_mfma_f32_32x32x16_bf16 a[0:15], a[92:95], v[68:71], a[0:15]
    ds_read_b64_tr_b16 a[84:85], v4 offset:0
    ds_read_b64_tr_b16 a[86:87], v4 offset:1280
    s_waitcnt lgkmcnt(10)
    v_mfma_f32_32x32x16_bf16 a[64:79], a[96:99], v[72:75], a[64:79]
    ds_read_b64_tr_b16 a[88:89], v4 offset:5376
    ds_read_b64_tr_b16 a[90:91], v4 offset:6656
    s_waitcnt lgkmcnt(10)
    v_mfma_f32_32x32x16_bf16 a[0:15], a[100:103], v[72:75], a[0:15]
    ds_read_b64_tr_b16 a[92:93], v4 offset:5120
    ds_read_b64_tr_b16 a[94:95], v4 offset:6400
    s_waitcnt lgkmcnt(10)
    v_mfma_f32_32x32x16_bf16 a[64:79], a[104:107], v[76:79], a[64:79]
    ds_read_b64_tr_b16 a[96:97], v4 offset:10496
    ds_read_b64_tr_b16 a[98:99], v4 offset:11776
    s_waitcnt lgkmcnt(10)
    v_mfma_f32_32x32x16_bf16 a[0:15], a[108:111], v[76:79], a[0:15]
    ds_read_b64_tr_b16 a[100:101], v4 offset:10240
    ds_read_b64_tr_b16 a[102:103], v4 offset:11520
    s_waitcnt lgkmcnt(10)
    s_waitcnt vmcnt(8)
    v_mfma_f32_32x32x16_bf16 a[64:79], a[80:83], v[80:83], a[64:79]
    ds_read_b64_tr_b16 a[104:105], v4 offset:15616
    ds_read_b64_tr_b16 a[106:107], v4 offset:16896
    s_waitcnt lgkmcnt(10)
    v_mfma_f32_32x32x16_bf16 a[0:15], a[84:87], v[80:83], a[0:15]
    ds_read_b64_tr_b16 a[108:109], v4 offset:15360
    ds_read_b64_tr_b16 a[110:111], v4 offset:16640
    s_waitcnt lgkmcnt(10)
    v_mfma_f32_32x32x16_bf16 a[64:79], a[88:91], v[84:87], a[64:79]
    ds_read_b64_tr_b16 a[80:81], v5 offset:256
    ds_read_b64_tr_b16 a[82:83], v5 offset:1536
    s_waitcnt lgkmcnt(10)
    v_mfma_f32_32x32x16_bf16 a[0:15], a[92:95], v[84:87], a[0:15]
    ds_read_b64_tr_b16 a[84:85], v5 offset:0
    ds_read_b64_tr_b16 a[86:87], v5 offset:1280
    s_waitcnt lgkmcnt(10)
    v_mfma_f32_32x32x16_bf16 a[64:79], a[96:99], v[88:91], a[64:79]
    ds_read_b64_tr_b16 a[88:89], v5 offset:5376
    ds_read_b64_tr_b16 a[90:91], v5 offset:6656
    s_waitcnt lgkmcnt(10)
    v_mfma_f32_32x32x16_bf16 a[0:15], a[100:103], v[88:91], a[0:15]
    ds_read_b64_tr_b16 a[92:93], v5 offset:5120
    ds_read_b64_tr_b16 a[94:95], v5 offset:6400
    s_waitcnt lgkmcnt(10)
    v_mfma_f32_32x32x16_bf16 a[64:79], a[104:107], v[92:95], a[64:79]
    ds_read_b64_tr_b16 a[96:97], v5 offset:10496
    ds_read_b64_tr_b16 a[98:99], v5 offset:11776
    s_waitcnt lgkmcnt(10)
    v_mfma_f32_32x32x16_bf16 a[0:15], a[108:111], v[92:95], a[0:15]
    ds_read_b64_tr_b16 a[100:101], v5 offset:10240
    ds_read_b64_tr_b16 a[102:103], v5 offset:11520
    s_waitcnt lgkmcnt(10)
    v_mfma_f32_32x32x16_bf16 a[64:79], a[80:83], v[96:99], a[64:79]
    ds_read_b64_tr_b16 a[104:105], v5 offset:15616
    ds_read_b64_tr_b16 a[106:107], v5 offset:16896
    s_waitcnt lgkmcnt(10)
    v_mfma_f32_32x32x16_bf16 a[0:15], a[84:87], v[96:99], a[0:15]
    ds_read_b64_tr_b16 a[108:109], v5 offset:15360
    ds_read_b64_tr_b16 a[110:111], v5 offset:16640
    s_waitcnt lgkmcnt(10)
    v_mfma_f32_32x32x16_bf16 a[64:79], a[88:91], v[100:103], a[64:79]
    ds_read_b64_tr_b16 a[80:81], v6 offset:256
    ds_read_b64_tr_b16 a[82:83], v6 offset:1536
    s_waitcnt lgkmcnt(10)
    v_mfma_f32_32x32x16_bf16 a[0:15], a[92:95], v[100:103], a[0:15]
    ds_read_b64_tr_b16 a[84:85], v6 offset:0
    ds_read_b64_tr_b16 a[86:87], v6 offset:1280
    s_waitcnt lgkmcnt(10)
    v_mfma_f32_32x32x16_bf16 a[64:79], a[96:99], v[104:107], a[64:79]
    ds_read_b64_tr_b16 a[88:89], v6 offset:5376
    ds_read_b64_tr_b16 a[90:91], v6 offset:6656
    s_waitcnt lgkmcnt(10)
    v_mfma_f32_32x32x16_bf16 a[0:15], a[100:103], v[104:107], a[0:15]
    ds_read_b64_tr_b16 a[92:93], v6 offset:5120
    ds_read_b64_tr_b16 a[94:95], v6 offset:6400
    s_waitcnt lgkmcnt(10)
    v_mfma_f32_32x32x16_bf16 a[64:79], a[104:107], v[108:111], a[64:79]
    ds_read_b64_tr_b16 a[96:97], v6 offset:10496
    ds_read_b64_tr_b16 a[98:99], v6 offset:11776
    s_waitcnt lgkmcnt(10)
    v_mfma_f32_32x32x16_bf16 a[0:15], a[108:111], v[108:111], a[0:15]
    ds_read_b64_tr_b16 a[100:101], v6 offset:10240
    ds_read_b64_tr_b16 a[102:103], v6 offset:11520
    s_waitcnt lgkmcnt(10)
    s_waitcnt vmcnt(0)
    v_mfma_f32_32x32x16_bf16 a[64:79], a[80:83], v[112:115], a[64:79]
    ds_read_b64_tr_b16 a[104:105], v6 offset:15616
    ds_read_b64_tr_b16 a[106:107], v6 offset:16896
    s_waitcnt lgkmcnt(10)
    v_mfma_f32_32x32x16_bf16 a[0:15], a[84:87], v[112:115], a[0:15]
    ds_read_b64_tr_b16 a[108:109], v6 offset:15360
    ds_read_b64_tr_b16 a[110:111], v6 offset:16640
    s_waitcnt lgkmcnt(10)
    v_mfma_f32_32x32x16_bf16 a[64:79], a[88:91], v[116:119], a[64:79]
    ds_read_b64_tr_b16 a[80:81], v7 offset:256
    ds_read_b64_tr_b16 a[82:83], v7 offset:1536
    s_waitcnt lgkmcnt(10)
    v_mfma_f32_32x32x16_bf16 a[0:15], a[92:95], v[116:119], a[0:15]
    ds_read_b64_tr_b16 a[84:85], v7 offset:0
    ds_read_b64_tr_b16 a[86:87], v7 offset:1280
    s_waitcnt lgkmcnt(10)
    v_mfma_f32_32x32x16_bf16 a[64:79], a[96:99], v[120:123], a[64:79]
    ds_read_b64_tr_b16 a[88:89], v7 offset:5376
    ds_read_b64_tr_b16 a[90:91], v7 offset:6656
    s_waitcnt lgkmcnt(10)
    v_mfma_f32_32x32x16_bf16 a[0:15], a[100:103], v[120:123], a[0:15]
    ds_read_b64_tr_b16 a[92:93], v7 offset:5120
    ds_read_b64_tr_b16 a[94:95], v7 offset:6400
    s_waitcnt lgkmcnt(10)
    v_mfma_f32_32x32x16_bf16 a[64:79], a[104:107], v[124:127], a[64:79]
    ds_read_b64_tr_b16 a[96:97], v7 offset:10496
    ds_read_b64_tr_b16 a[98:99], v7 offset:11776
    s_waitcnt lgkmcnt(10)
    v_mfma_f32_32x32x16_bf16 a[0:15], a[108:111], v[124:127], a[0:15]
    ds_read_b64_tr_b16 a[100:101], v7 offset:10240
    ds_read_b64_tr_b16 a[102:103], v7 offset:11520
    s_waitcnt lgkmcnt(10)
    v_mfma_f32_32x32x16_bf16 a[64:79], a[80:83], v[128:131], a[64:79]
    ds_read_b64_tr_b16 a[104:105], v7 offset:15616
    ds_read_b64_tr_b16 a[106:107], v7 offset:16896
    s_waitcnt lgkmcnt(10)
    v_mfma_f32_32x32x16_bf16 a[0:15], a[84:87], v[128:131], a[0:15]
    ds_read_b64_tr_b16 a[108:109], v7 offset:15360
    ds_read_b64_tr_b16 a[110:111], v7 offset:16640
    s_waitcnt lgkmcnt(10)
    v_mfma_f32_32x32x16_bf16 a[64:79], a[88:91], v[132:135], a[64:79]
    ds_read_b64_tr_b16 a[80:81], v2 offset:64
    ds_read_b64_tr_b16 a[82:83], v2 offset:1344
    s_waitcnt lgkmcnt(10)
    v_mfma_f32_32x32x16_bf16 a[0:15], a[92:95], v[132:135], a[0:15]
    ds_read_b64_tr_b16 a[84:85], v2 offset:128
    ds_read_b64_tr_b16 a[86:87], v2 offset:1408
    s_waitcnt lgkmcnt(10)
    v_mfma_f32_32x32x16_bf16 a[64:79], a[96:99], v[136:139], a[64:79]
    ds_read_b64_tr_b16 a[88:89], v2 offset:5184
    ds_read_b64_tr_b16 a[90:91], v2 offset:6464
    s_waitcnt lgkmcnt(10)
    v_mfma_f32_32x32x16_bf16 a[0:15], a[100:103], v[136:139], a[0:15]
    ds_read_b64_tr_b16 a[92:93], v2 offset:5248
    ds_read_b64_tr_b16 a[94:95], v2 offset:6528
    s_waitcnt lgkmcnt(10)
    v_mfma_f32_32x32x16_bf16 a[64:79], a[104:107], v[140:143], a[64:79]
    ds_read_b64_tr_b16 a[96:97], v2 offset:10304
    ds_read_b64_tr_b16 a[98:99], v2 offset:11584
    s_waitcnt lgkmcnt(10)
    v_mfma_f32_32x32x16_bf16 a[0:15], a[108:111], v[140:143], a[0:15]
    ds_read_b64_tr_b16 a[100:101], v2 offset:10368
    ds_read_b64_tr_b16 a[102:103], v2 offset:11648
    s_waitcnt lgkmcnt(10)
    v_mfma_f32_32x32x16_bf16 a[16:31], a[80:83], v[48:51], a[16:31]
    ds_read_b64_tr_b16 a[104:105], v2 offset:15424
    ds_read_b64_tr_b16 a[106:107], v2 offset:16704
    s_waitcnt lgkmcnt(10)
    v_mfma_f32_32x32x16_bf16 a[32:47], a[84:87], v[48:51], a[32:47]
    ds_read_b64_tr_b16 a[108:109], v2 offset:15488
    ds_read_b64_tr_b16 a[110:111], v2 offset:16768
    s_waitcnt lgkmcnt(10)
    v_mfma_f32_32x32x16_bf16 a[16:31], a[88:91], v[52:55], a[16:31]
    ds_read_b64_tr_b16 a[80:81], v3 offset:64
    ds_read_b64_tr_b16 a[82:83], v3 offset:1344
    s_waitcnt lgkmcnt(10)
    v_mfma_f32_32x32x16_bf16 a[32:47], a[92:95], v[52:55], a[32:47]
    ds_read_b64_tr_b16 a[84:85], v3 offset:128
    ds_read_b64_tr_b16 a[86:87], v3 offset:1408
    s_waitcnt lgkmcnt(10)
    v_mfma_f32_32x32x16_bf16 a[16:31], a[96:99], v[56:59], a[16:31]
    ds_read_b64_tr_b16 a[88:89], v3 offset:5184
    ds_read_b64_tr_b16 a[90:91], v3 offset:6464
    s_waitcnt lgkmcnt(10)
    v_mfma_f32_32x32x16_bf16 a[32:47], a[100:103], v[56:59], a[32:47]
    ds_read_b64_tr_b16 a[92:93], v3 offset:5248
    ds_read_b64_tr_b16 a[94:95], v3 offset:6528
    s_add_u32 s38, s80, 4096
    buffer_store_dwordx4 a[64:67], v42, s[24:27], s38 offen sc1
    s_add_u32 s38, s80, 65536
    s_waitcnt lgkmcnt(10)
    v_mfma_f32_32x32x16_bf16 a[16:31], a[104:107], v[60:63], a[16:31]
    ds_read_b64_tr_b16 a[96:97], v3 offset:10304
    ds_read_b64_tr_b16 a[98:99], v3 offset:11584
    buffer_store_dwordx4 a[68:71], v42, s[24:27], s38 offen sc1
    s_add_u32 s38, s80, 126976
    buffer_store_dwordx4 a[72:75], v42, s[24:27], s38 offen sc1
    s_waitcnt lgkmcnt(10)
    v_mfma_f32_32x32x16_bf16 a[32:47], a[108:111], v[60:63], a[32:47]
    ds_read_b64_tr_b16 a[100:101], v3 offset:10368
    ds_read_b64_tr_b16 a[102:103], v3 offset:11648
    s_add_u32 s38, s80, 0
    buffer_store_dwordx4 a[0:3], v42, s[24:27], s38 offen offset:0 sc1
    buffer_store_dwordx4 a[4:7], v42, s[24:27], s38 offen offset:1024 sc1
    s_waitcnt lgkmcnt(10)
    v_mfma_f32_32x32x16_bf16 a[16:31], a[80:83], v[64:67], a[16:31]
    ds_read_b64_tr_b16 a[104:105], v3 offset:15424
    ds_read_b64_tr_b16 a[106:107], v3 offset:16704
    buffer_store_dwordx4 a[8:11], v42, s[24:27], s38 offen offset:2048 sc1
    buffer_store_dwordx4 a[12:15], v42, s[24:27], s38 offen offset:3072 sc1
    s_waitcnt lgkmcnt(10)
    v_mfma_f32_32x32x16_bf16 a[32:47], a[84:87], v[64:67], a[32:47]
    ds_read_b64_tr_b16 a[108:109], v3 offset:15488
    ds_read_b64_tr_b16 a[110:111], v3 offset:16768
    s_waitcnt lgkmcnt(10)
    v_mfma_f32_32x32x16_bf16 a[16:31], a[88:91], v[68:71], a[16:31]
    ds_read_b64_tr_b16 a[80:81], v4 offset:64
    ds_read_b64_tr_b16 a[82:83], v4 offset:1344
    s_waitcnt lgkmcnt(10)
    v_mfma_f32_32x32x16_bf16 a[32:47], a[92:95], v[68:71], a[32:47]
    ds_read_b64_tr_b16 a[84:85], v4 offset:128
    ds_read_b64_tr_b16 a[86:87], v4 offset:1408
    s_waitcnt lgkmcnt(10)
    v_mfma_f32_32x32x16_bf16 a[16:31], a[96:99], v[72:75], a[16:31]
    ds_read_b64_tr_b16 a[88:89], v4 offset:5184
    ds_read_b64_tr_b16 a[90:91], v4 offset:6464
    s_waitcnt lgkmcnt(10)
    v_mfma_f32_32x32x16_bf16 a[32:47], a[100:103], v[72:75], a[32:47]
    ds_read_b64_tr_b16 a[92:93], v4 offset:5248
    ds_read_b64_tr_b16 a[94:95], v4 offset:6528
    s_waitcnt lgkmcnt(10)
    v_mfma_f32_32x32x16_bf16 a[16:31], a[104:107], v[76:79], a[16:31]
    ds_read_b64_tr_b16 a[96:97], v4 offset:10304
    ds_read_b64_tr_b16 a[98:99], v4 offset:11584
    s_waitcnt lgkmcnt(10)
    v_mfma_f32_32x32x16_bf16 a[32:47], a[108:111], v[76:79], a[32:47]
    ds_read_b64_tr_b16 a[100:101], v4 offset:10368
    ds_read_b64_tr_b16 a[102:103], v4 offset:11648
    s_waitcnt lgkmcnt(10)
    v_mfma_f32_32x32x16_bf16 a[16:31], a[80:83], v[80:83], a[16:31]
    ds_read_b64_tr_b16 a[104:105], v4 offset:15424
    ds_read_b64_tr_b16 a[106:107], v4 offset:16704
    s_waitcnt lgkmcnt(10)
    v_mfma_f32_32x32x16_bf16 a[32:47], a[84:87], v[80:83], a[32:47]
    ds_read_b64_tr_b16 a[108:109], v4 offset:15488
    ds_read_b64_tr_b16 a[110:111], v4 offset:16768
    s_waitcnt lgkmcnt(10)
    v_mfma_f32_32x32x16_bf16 a[16:31], a[88:91], v[84:87], a[16:31]
    ds_read_b64_tr_b16 a[80:81], v5 offset:64
    ds_read_b64_tr_b16 a[82:83], v5 offset:1344
    s_waitcnt lgkmcnt(10)
    v_mfma_f32_32x32x16_bf16 a[32:47], a[92:95], v[84:87], a[32:47]
    ds_read_b64_tr_b16 a[84:85], v5 offset:128
    ds_read_b64_tr_b16 a[86:87], v5 offset:1408
    s_waitcnt lgkmcnt(10)
    v_mfma_f32_32x32x16_bf16 a[16:31], a[96:99], v[88:91], a[16:31]
    ds_read_b64_tr_b16 a[88:89], v5 offset:5184
    ds_read_b64_tr_b16 a[90:91], v5 offset:6464
    s_waitcnt lgkmcnt(10)
    v_mfma_f32_32x32x16_bf16 a[32:47], a[100:103], v[88:91], a[32:47]
    ds_read_b64_tr_b16 a[92:93], v5 offset:5248
    ds_read_b64_tr_b16 a[94:95], v5 offset:6528
    s_waitcnt lgkmcnt(10)
    v_mfma_f32_32x32x16_bf16 a[16:31], a[104:107], v[92:95], a[16:31]
    ds_read_b64_tr_b16 a[96:97], v5 offset:10304
    ds_read_b64_tr_b16 a[98:99], v5 offset:11584
    s_waitcnt lgkmcnt(10)
    v_mfma_f32_32x32x16_bf16 a[32:47], a[108:111], v[92:95], a[32:47]
    ds_read_b64_tr_b16 a[100:101], v5 offset:10368
    ds_read_b64_tr_b16 a[102:103], v5 offset:11648
    s_waitcnt lgkmcnt(10)
    v_mfma_f32_32x32x16_bf16 a[16:31], a[80:83], v[96:99], a[16:31]
    ds_read_b64_tr_b16 a[104:105], v5 offset:15424
    ds_read_b64_tr_b16 a[106:107], v5 offset:16704
    s_waitcnt lgkmcnt(10)
    v_mfma_f32_32x32x16_bf16 a[32:47], a[84:87], v[96:99], a[32:47]
    ds_read_b64_tr_b16 a[108:109], v5 offset:15488
    ds_read_b64_tr_b16 a[110:111], v5 offset:16768
    s_waitcnt lgkmcnt(10)
    v_mfma_f32_32x32x16_bf16 a[16:31], a[88:91], v[100:103], a[16:31]
    ds_read_b64_tr_b16 a[80:81], v6 offset:64
    ds_read_b64_tr_b16 a[82:83], v6 offset:1344
    s_waitcnt lgkmcnt(10)
    v_mfma_f32_32x32x16_bf16 a[32:47], a[92:95], v[100:103], a[32:47]
    ds_read_b64_tr_b16 a[84:85], v6 offset:128
    ds_read_b64_tr_b16 a[86:87], v6 offset:1408
    s_waitcnt lgkmcnt(10)
    v_mfma_f32_32x32x16_bf16 a[16:31], a[96:99], v[104:107], a[16:31]
    ds_read_b64_tr_b16 a[88:89], v6 offset:5184
    ds_read_b64_tr_b16 a[90:91], v6 offset:6464
    s_waitcnt lgkmcnt(10)
    v_mfma_f32_32x32x16_bf16 a[32:47], a[100:103], v[104:107], a[32:47]
    ds_read_b64_tr_b16 a[92:93], v6 offset:5248
    ds_read_b64_tr_b16 a[94:95], v6 offset:6528
    s_waitcnt lgkmcnt(10)
    v_mfma_f32_32x32x16_bf16 a[16:31], a[104:107], v[108:111], a[16:31]
    ds_read_b64_tr_b16 a[96:97], v6 offset:10304
    ds_read_b64_tr_b16 a[98:99], v6 offset:11584
    s_waitcnt lgkmcnt(10)
    v_mfma_f32_32x32x16_bf16 a[32:47], a[108:111], v[108:111], a[32:47]
    ds_read_b64_tr_b16 a[100:101], v6 offset:10368
    ds_read_b64_tr_b16 a[102:103], v6 offset:11648
    s_waitcnt lgkmcnt(10)
    v_mfma_f32_32x32x16_bf16 a[16:31], a[80:83], v[112:115], a[16:31]
    ds_read_b64_tr_b16 a[104:105], v6 offset:15424
    ds_read_b64_tr_b16 a[106:107], v6 offset:16704
    s_waitcnt lgkmcnt(10)
    v_mfma_f32_32x32x16_bf16 a[32:47], a[84:87], v[112:115], a[32:47]
    ds_read_b64_tr_b16 a[108:109], v6 offset:15488
    ds_read_b64_tr_b16 a[110:111], v6 offset:16768
    s_waitcnt lgkmcnt(10)
    v_mfma_f32_32x32x16_bf16 a[16:31], a[88:91], v[116:119], a[16:31]
    ds_read_b64_tr_b16 a[80:81], v7 offset:64
    ds_read_b64_tr_b16 a[82:83], v7 offset:1344
    s_waitcnt lgkmcnt(10)
    v_mfma_f32_32x32x16_bf16 a[32:47], a[92:95], v[116:119], a[32:47]
    ds_read_b64_tr_b16 a[84:85], v7 offset:128
    ds_read_b64_tr_b16 a[86:87], v7 offset:1408
    s_waitcnt lgkmcnt(10)
    v_mfma_f32_32x32x16_bf16 a[16:31], a[96:99], v[120:123], a[16:31]
    ds_read_b64_tr_b16 a[88:89], v7 offset:5184
    ds_read_b64_tr_b16 a[90:91], v7 offset:6464
    s_waitcnt lgkmcnt(10)
    v_mfma_f32_32x32x16_bf16 a[32:47], a[100:103], v[120:123], a[32:47]
    ds_read_b64_tr_b16 a[92:93], v7 offset:5248
    ds_read_b64_tr_b16 a[94:95], v7 offset:6528
    s_waitcnt lgkmcnt(10)
    v_mfma_f32_32x32x16_bf16 a[16:31], a[104:107], v[124:127], a[16:31]
    ds_read_b64_tr_b16 a[96:97], v7 offset:10304
    ds_read_b64_tr_b16 a[98:99], v7 offset:11584
    s_waitcnt lgkmcnt(10)
    v_mfma_f32_32x32x16_bf16 a[32:47], a[108:111], v[124:127], a[32:47]
    ds_read_b64_tr_b16 a[100:101], v7 offset:10368
    ds_read_b64_tr_b16 a[102:103], v7 offset:11648
    s_waitcnt lgkmcnt(10)
    v_mfma_f32_32x32x16_bf16 a[16:31], a[80:83], v[128:131], a[16:31]
    ds_read_b64_tr_b16 a[104:105], v7 offset:15424
    ds_read_b64_tr_b16 a[106:107], v7 offset:16704
    s_waitcnt lgkmcnt(10)
    v_mfma_f32_32x32x16_bf16 a[32:47], a[84:87], v[128:131], a[32:47]
    ds_read_b64_tr_b16 a[108:109], v7 offset:15488
    ds_read_b64_tr_b16 a[110:111], v7 offset:16768
    s_waitcnt lgkmcnt(10)
    v_mfma_f32_32x32x16_bf16 a[16:31], a[88:91], v[132:135], a[16:31]
    ds_read_b64_tr_b16 a[80:81], v2 offset:192
    ds_read_b64_tr_b16 a[82:83], v2 offset:1472
    s_waitcnt lgkmcnt(10)
    v_mfma_f32_32x32x16_bf16 a[32:47], a[92:95], v[132:135], a[32:47]
    ds_read_b64_tr_b16 a[84:85], v2 offset:5312
    ds_read_b64_tr_b16 a[86:87], v2 offset:6592
    s_waitcnt lgkmcnt(10)
    v_mfma_f32_32x32x16_bf16 a[16:31], a[96:99], v[136:139], a[16:31]
    ds_read_b64_tr_b16 a[88:89], v2 offset:10432
    ds_read_b64_tr_b16 a[90:91], v2 offset:11712
    s_waitcnt lgkmcnt(10)
    v_mfma_f32_32x32x16_bf16 a[32:47], a[100:103], v[136:139], a[32:47]
    ds_read_b64_tr_b16 a[92:93], v2 offset:15552
    ds_read_b64_tr_b16 a[94:95], v2 offset:16832
    s_waitcnt lgkmcnt(10)
    v_mfma_f32_32x32x16_bf16 a[16:31], a[104:107], v[140:143], a[16:31]
    ds_read_b64_tr_b16 a[96:97], v3 offset:192
    ds_read_b64_tr_b16 a[98:99], v3 offset:1472
    s_waitcnt lgkmcnt(10)
    v_mfma_f32_32x32x16_bf16 a[32:47], a[108:111], v[140:143], a[32:47]
    ds_read_b64_tr_b16 a[100:101], v3 offset:5312
    ds_read_b64_tr_b16 a[102:103], v3 offset:6592
    s_waitcnt lgkmcnt(10)
    v_mfma_f32_32x32x16_bf16 a[48:63], a[80:83], v[48:51], a[48:63]
    ds_read_b64_tr_b16 a[104:105], v3 offset:10432
    ds_read_b64_tr_b16 a[106:107], v3 offset:11712
    s_waitcnt lgkmcnt(10)
    v_mfma_f32_32x32x16_bf16 a[48:63], a[84:87], v[52:55], a[48:63]
    ds_read_b64_tr_b16 a[108:109], v3 offset:15552
    ds_read_b64_tr_b16 a[110:111], v3 offset:16832
    s_waitcnt lgkmcnt(10)
    v_mfma_f32_32x32x16_bf16 a[48:63], a[88:91], v[56:59], a[48:63]
    ds_read_b64_tr_b16 a[80:81], v4 offset:192
    ds_read_b64_tr_b16 a[82:83], v4 offset:1472
    s_waitcnt lgkmcnt(10)
    v_mfma_f32_32x32x16_bf16 a[48:63], a[92:95], v[60:63], a[48:63]
    ds_read_b64_tr_b16 a[84:85], v4 offset:5312
    ds_read_b64_tr_b16 a[86:87], v4 offset:6592
    s_waitcnt lgkmcnt(10)
    v_mfma_f32_32x32x16_bf16 a[48:63], a[96:99], v[64:67], a[48:63]
    ds_read_b64_tr_b16 a[88:89], v4 offset:10432
    ds_read_b64_tr_b16 a[90:91], v4 offset:11712
    s_waitcnt lgkmcnt(10)
    v_mfma_f32_32x32x16_bf16 a[48:63], a[100:103], v[68:71], a[48:63]
    ds_read_b64_tr_b16 a[92:93], v4 offset:15552
    ds_read_b64_tr_b16 a[94:95], v4 offset:16832
    s_add_u32 s38, s80, 61440
    buffer_store_dwordx4 a[16:19], v42, s[24:27], s38 offen offset:0 sc1
    buffer_store_dwordx4 a[20:23], v42, s[24:27], s38 offen offset:1024 sc1
    s_waitcnt lgkmcnt(10)
    v_mfma_f32_32x32x16_bf16 a[48:63], a[104:107], v[72:75], a[48:63]
    ds_read_b64_tr_b16 a[96:97], v5 offset:192
    ds_read_b64_tr_b16 a[98:99], v5 offset:1472
    buffer_store_dwordx4 a[24:27], v42, s[24:27], s38 offen offset:2048 sc1
    buffer_store_dwordx4 a[28:31], v42, s[24:27], s38 offen offset:3072 sc1
    s_add_u32 s38, s80, 122880
    s_waitcnt lgkmcnt(10)
    v_mfma_f32_32x32x16_bf16 a[48:63], a[108:111], v[76:79], a[48:63]
    ds_read_b64_tr_b16 a[100:101], v5 offset:5312
    ds_read_b64_tr_b16 a[102:103], v5 offset:6592
    buffer_store_dwordx4 a[32:35], v42, s[24:27], s38 offen offset:0 sc1
    buffer_store_dwordx4 a[36:39], v42, s[24:27], s38 offen offset:1024 sc1
    buffer_store_dwordx4 a[40:43], v42, s[24:27], s38 offen offset:2048 sc1
    s_waitcnt lgkmcnt(10)
    v_mfma_f32_32x32x16_bf16 a[48:63], a[80:83], v[80:83], a[48:63]
    ds_read_b64_tr_b16 a[104:105], v5 offset:10432
    ds_read_b64_tr_b16 a[106:107], v5 offset:11712
    buffer_store_dwordx4 a[44:47], v42, s[24:27], s38 offen offset:3072 sc1
    s_waitcnt lgkmcnt(10)
    v_mfma_f32_32x32x16_bf16 a[48:63], a[84:87], v[84:87], a[48:63]
    ds_read_b64_tr_b16 a[108:109], v5 offset:15552
    ds_read_b64_tr_b16 a[110:111], v5 offset:16832
    s_waitcnt lgkmcnt(10)
    v_mfma_f32_32x32x16_bf16 a[48:63], a[88:91], v[88:91], a[48:63]
    ds_read_b64_tr_b16 a[80:81], v6 offset:192
    ds_read_b64_tr_b16 a[82:83], v6 offset:1472
    s_waitcnt lgkmcnt(10)
    v_mfma_f32_32x32x16_bf16 a[48:63], a[92:95], v[92:95], a[48:63]
    ds_read_b64_tr_b16 a[84:85], v6 offset:5312
    ds_read_b64_tr_b16 a[86:87], v6 offset:6592
    s_waitcnt lgkmcnt(10)
    v_mfma_f32_32x32x16_bf16 a[48:63], a[96:99], v[96:99], a[48:63]
    ds_read_b64_tr_b16 a[88:89], v6 offset:10432
    ds_read_b64_tr_b16 a[90:91], v6 offset:11712
    s_waitcnt lgkmcnt(10)
    v_mfma_f32_32x32x16_bf16 a[48:63], a[100:103], v[100:103], a[48:63]
    ds_read_b64_tr_b16 a[92:93], v6 offset:15552
    ds_read_b64_tr_b16 a[94:95], v6 offset:16832
    s_waitcnt lgkmcnt(10)
    v_mfma_f32_32x32x16_bf16 a[48:63], a[104:107], v[104:107], a[48:63]
    ds_read_b64_tr_b16 a[96:97], v7 offset:192
    ds_read_b64_tr_b16 a[98:99], v7 offset:1472
    s_waitcnt lgkmcnt(10)
    v_mfma_f32_32x32x16_bf16 a[48:63], a[108:111], v[108:111], a[48:63]
    ds_read_b64_tr_b16 a[100:101], v7 offset:5312
    ds_read_b64_tr_b16 a[102:103], v7 offset:6592
    s_waitcnt lgkmcnt(10)
    v_mfma_f32_32x32x16_bf16 a[48:63], a[80:83], v[112:115], a[48:63]
    ds_read_b64_tr_b16 a[104:105], v7 offset:10432
    ds_read_b64_tr_b16 a[106:107], v7 offset:11712
    s_waitcnt lgkmcnt(10)
    v_mfma_f32_32x32x16_bf16 a[48:63], a[84:87], v[116:119], a[48:63]
    ds_read_b64_tr_b16 a[108:109], v7 offset:15552
    ds_read_b64_tr_b16 a[110:111], v7 offset:16832
    s_waitcnt lgkmcnt(10)
    v_mfma_f32_32x32x16_bf16 a[48:63], a[88:91], v[120:123], a[48:63]
    s_waitcnt lgkmcnt(8)
    v_mfma_f32_32x32x16_bf16 a[48:63], a[92:95], v[124:127], a[48:63]
    s_waitcnt lgkmcnt(6)
    v_mfma_f32_32x32x16_bf16 a[48:63], a[96:99], v[128:131], a[48:63]
    s_waitcnt lgkmcnt(4)
    v_mfma_f32_32x32x16_bf16 a[48:63], a[100:103], v[132:135], a[48:63]
    s_waitcnt lgkmcnt(2)
    v_mfma_f32_32x32x16_bf16 a[48:63], a[104:107], v[136:139], a[48:63]
    s_waitcnt lgkmcnt(0)
    v_mfma_f32_32x32x16_bf16 a[48:63], a[108:111], v[140:143], a[48:63]
    s_nop 7
    s_nop 7
    v_accvgpr_read_b32 v48, a48
    v_accvgpr_read_b32 v49, a49
    v_accvgpr_read_b32 v50, a50
    v_accvgpr_read_b32 v51, a51
    v_accvgpr_read_b32 v52, a52
    v_accvgpr_read_b32 v53, a53
    v_accvgpr_read_b32 v54, a54
    v_accvgpr_read_b32 v55, a55
    v_accvgpr_read_b32 v56, a56
    v_accvgpr_read_b32 v57, a57
    v_accvgpr_read_b32 v58, a58
    v_accvgpr_read_b32 v59, a59
    v_accvgpr_read_b32 v60, a60
    v_accvgpr_read_b32 v61, a61
    v_accvgpr_read_b32 v62, a62
    v_accvgpr_read_b32 v63, a63
    v_accvgpr_read_b32 v64, a76
    v_accvgpr_read_b32 v65, a77
    v_accvgpr_read_b32 v66, a78
    v_accvgpr_read_b32 v67, a79
    s_branch L_tm_done
L_tm_skip3:
L_tm_done:
    s_waitcnt vmcnt(0)
    s_lshl_b32 s38, s33, 2
    s_lshl_b32 s39, s3, 4
    s_add_u32 s38, s38, s39
    s_add_u32 s38, s38, s65
    v_mov_b32 v44, s71
    s_mov_b64 exec, 1
    buffer_store_dword v44, v43, s[24:27], s38 offen sc1
    s_mov_b64 exec, -1
    v_and_b32 v5, 31, v1
    v_lshrrev_b32 v6, 5, v1
    s_mul_i32 s36, s34, 96
    s_lshl_b32 s37, s3, 5
    s_add_u32 s36, s36, s37
    v_add_u32 v5, s36, v5
    s_movk_i32 s37, 2560
    v_mul_lo_u32 v5, v5, s37
    v_lshl_add_u32 v5, v6, 4, v5
    s_mul_i32 s80, s32, 1280
    s_mul_i32 s37, s35, 320
    s_add_u32 s80, s80, s37
    s_mul_i32 s38, s33, 61440
    s_add_u32 s79, s79, s38
    s_lshl_b32 s39, s3, 4
    s_add_u32 s39, s39, s65
    s_mov_b32 s37, 0
    v_and_b32 v8, 3, v1
    v_lshlrev_b32 v8, 2, v8
    buffer_load_dword v44, v8, s[24:27], s39 offen sc1
L_pw_f3:
    s_waitcnt vmcnt(0)
    v_cmp_ne_u32 vcc, s71, v44
    s_nop 0
    s_cbranch_vccz L_pw_f3_done
    buffer_load_dword v44, v8, s[24:27], s39 offen sc1
    s_add_u32 s37, s37, 1
    s_cmp_lt_u32 s37, 50000
    s_cbranch_scc1 L_pw_f3
L_pw_f3_done:
    s_add_u32 s38, s33, 1
    s_and_b32 s38, s38, 3
    s_mul_i32 s38, s38, 15360
    s_add_u32 s38, s38, s79
    buffer_load_dwordx4 v[68:71], v42, s[24:27], s38 offen offset:0
    buffer_load_dwordx4 v[72:75], v42, s[24:27], s38 offen offset:1024
    buffer_load_dwordx4 v[76:79], v42, s[24:27], s38 offen offset:2048
    buffer_load_dwordx4 v[80:83], v42, s[24:27], s38 offen offset:3072
    s_add_u32 s38, s38, 4096
    buffer_load_dwordx4 v[84:87], v42, s[24:27], s38 offen offset:0
    s_add_u32 s38, s33, 2
    s_and_b32 s38, s38, 3
    s_mul_i32 s38, s38, 15360
    s_add_u32 s38, s38, s79
    buffer_load_dwordx4 v[88:91], v42, s[24:27], s38 offen offset:0
    buffer_load_dwordx4 v[92:95], v42, s[24:27], s38 offen offset:1024
    buffer_load_dwordx4 v[96:99], v42, s[24:27], s38 offen offset:2048
    buffer_load_dwordx4 v[100:103], v42, s[24:27], s38 offen offset:3072
    s_add_u32 s38, s38, 4096
    buffer_load_dwordx4 v[104:107], v42, s[24:27], s38 offen offset:0
    s_add_u32 s38, s33, 3
    s_and_b32 s38, s38, 3
    s_mul_i32 s38, s38, 15360
    s_add_u32 s38, s38, s79
    buffer_load_dwordx4 v[108:111], v42, s[24:27], s38 offen offset:0
    buffer_load_dwordx4 v[112:115], v42, s[24:27], s38 offen offset:1024
    buffer_load_dwordx4 v[116:119], v42, s[24:27], s38 offen offset:2048
    buffer_load_dwordx4 v[120:123], v42, s[24:27], s38 offen offset:3072
    s_add_u32 s38, s38, 4096
    buffer_load_dwordx4 v[124:127], v42, s[24:27], s38 offen offset:0
    s_lshl_b32 s36, s33, 6
    s_add_u32 s36, s36, s80
    s_lshr_b32 s37, s33, 1
    s_lshl_b32 s37, s37, 5
    s_and_b32 s38, s33, 1
    s_lshl_b32 s38, s38, 3
    s_add_u32 s37, s37, s38
    s_add_u32 s37, s37, s80
    s_add_u32 s37, s37, 256
    s_waitcnt vmcnt(0)
    v_pk_add_f32 v[48:49], v[48:49], v[68:69]
    v_pk_add_f32 v[88:89], v[88:89], v[108:109]
    v_pk_add_f32 v[48:49], v[48:49], v[88:89]
    v_pk_add_f32 v[50:51], v[50:51], v[70:71]
    v_pk_add_f32 v[90:91], v[90:91], v[110:111]
    v_pk_add_f32 v[50:51], v[50:51], v[90:91]
    v_pk_add_f32 v[52:53], v[52:53], v[72:73]
    v_pk_add_f32 v[92:93], v[92:93], v[112:113]
    v_pk_add_f32 v[52:53], v[52:53], v[92:93]
    v_pk_add_f32 v[54:55], v[54:55], v[74:75]
    v_pk_add_f32 v[94:95], v[94:95], v[114:115]
    v_pk_add_f32 v[54:55], v[54:55], v[94:95]
    v_pk_add_f32 v[56:57], v[56:57], v[76:77]
    v_pk_add_f32 v[96:97], v[96:97], v[116:117]
    v_pk_add_f32 v[56:57], v[56:57], v[96:97]
    v_pk_add_f32 v[58:59], v[58:59], v[78:79]
    v_pk_add_f32 v[98:99], v[98:99], v[118:119]
    v_pk_add_f32 v[58:59], v[58:59], v[98:99]
    v_pk_add_f32 v[60:61], v[60:61], v[80:81]
    v_pk_add_f32 v[100:101], v[100:101], v[120:121]
    v_pk_add_f32 v[60:61], v[60:61], v[100:101]
    v_pk_add_f32 v[62:63], v[62:63], v[82:83]
    v_pk_add_f32 v[102:103], v[102:103], v[122:123]
    v_pk_add_f32 v[62:63], v[62:63], v[102:103]
    v_pk_add_f32 v[64:65], v[64:65], v[84:85]
    v_pk_add_f32 v[104:105], v[104:105], v[124:125]
    v_pk_add_f32 v[64:65], v[64:65], v[104:105]
    v_pk_add_f32 v[66:67], v[66:67], v[86:87]
    v_pk_add_f32 v[106:107], v[106:107], v[126:127]
    v_pk_add_f32 v[66:67], v[66:67], v[106:107]
    v_cvt_pk_bf16_f32 v128, v48, v49
    v_cvt_pk_bf16_f32 v129, v50, v51
    v_cvt_pk_bf16_f32 v130, v52, v53
    v_cvt_pk_bf16_f32 v131, v54, v55
    v_cvt_pk_bf16_f32 v132, v56, v57
    v_cvt_pk_bf16_f32 v133, v58, v59
    v_cvt_pk_bf16_f32 v134, v60, v61
    v_cvt_pk_bf16_f32 v135, v62, v63
    v_cvt_pk_bf16_f32 v136, v64, v65
    v_cvt_pk_bf16_f32 v137, v66, v67
    buffer_store_dwordx4 v[128:131], v5, s[28:31], s36 offen
    buffer_store_dwordx4 v[132:135], v5, s[28:31], s36 offen offset:32
    buffer_store_dwordx2 v[136:137], v5, s[28:31], s37 offen
    s_waitcnt vmcnt(0)
    s_endpgm
L_uprol:
    s_waitcnt lgkmcnt(0)
    v_mfma_f32_32x32x16_bf16 v[48:63], a[192:195], v[112:115], 0
    v_mfma_f32_32x32x16_bf16 v[48:63], a[196:199], v[116:119], v[48:63]
    v_mfma_f32_32x32x16_bf16 v[48:63], a[200:203], v[120:123], v[48:63]
    v_mfma_f32_32x32x16_bf16 v[48:63], a[204:207], v[124:127], v[48:63]
    v_mfma_f32_32x32x16_bf16 v[48:63], a[208:211], v[128:131], v[48:63]
    v_mfma_f32_32x32x16_bf16 v[48:63], a[212:215], v[132:135], v[48:63]
    v_mfma_f32_32x32x16_bf16 v[48:63], a[216:219], v[136:139], v[48:63]
    v_mfma_f32_32x32x16_bf16 v[48:63], a[220:223], v[140:143], v[48:63]
    v_pk_mov_b32 v[104:105], 0, 0
    v_pk_mov_b32 v[106:107], 0, 0
    v_pk_mov_b32 v[108:109], 0, 0
    v_pk_mov_b32 v[110:111], 0, 0
    v_mov_b32 v36, 0
    s_nop 7
    v_max3_f32 v2, v48, v49, v50
    v_max3_f32 v2, v2, v51, v52
    v_max3_f32 v2, v2, v53, v54
    v_max3_f32 v2, v2, v55, v56
    v_max3_f32 v2, v2, v57, v58
    v_max3_f32 v2, v2, v59, v60
    v_max3_f32 v2, v2, v61, v62
    v_max_f32 v2, v2, v63
    v_mov_b32 v3, v2
    s_nop 1
    v_permlane32_swap_b32 v2, v3
    v_max_f32 v2, v2, v3
    v_sub_f32 v2, 0, v2
    v_mov_b32 v3, v2
    v_pk_mov_b32 v[80:81], v[2:3], v[2:3] op_sel:[0,1]
    v_pk_mov_b32 v[82:83], v[2:3], v[2:3] op_sel:[0,1]
    v_pk_mov_b32 v[84:85], v[2:3], v[2:3] op_sel:[0,1]
    v_pk_mov_b32 v[86:87], v[2:3], v[2:3] op_sel:[0,1]
    v_pk_mov_b32 v[88:89], v[2:3], v[2:3] op_sel:[0,1]
    v_pk_mov_b32 v[90:91], v[2:3], v[2:3] op_sel:[0,1]
    v_pk_mov_b32 v[92:93], v[2:3], v[2:3] op_sel:[0,1]
    v_pk_mov_b32 v[94:95], v[2:3], v[2:3] op_sel:[0,1]
    v_pk_add_f32 v[48:49], v[48:49], v[2:3]
    v_pk_add_f32 v[50:51], v[50:51], v[2:3]
    v_pk_add_f32 v[52:53], v[52:53], v[2:3]
    v_pk_add_f32 v[54:55], v[54:55], v[2:3]
    v_pk_add_f32 v[56:57], v[56:57], v[2:3]
    v_pk_add_f32 v[58:59], v[58:59], v[2:3]
    v_pk_add_f32 v[60:61], v[60:61], v[2:3]
    v_pk_add_f32 v[62:63], v[62:63], v[2:3]
    s_setpc_b64 s[66:67]
L_attn_q2:
    s_waitcnt lgkmcnt(0)
    v_mfma_f32_32x32x16_bf16 v[64:79], a[224:227], v[112:115], v[80:95]
    v_add_u32 v16, s74, v16
    v_add_u32 v17, s74, v17
    v_add_u32 v18, s74, v18
    v_add_u32 v19, s74, v19
    v_add_u32 v20, s74, v20
    v_add_u32 v21, s74, v21
    v_mfma_f32_32x32x16_bf16 v[176:191], a[160:163], v[104:107], v[176:191]
    v_add_u32 v22, s74, v22
    v_add_u32 v23, s74, v23
    v_add_u32 v24, s74, v24
    v_add_u32 v25, s74, v25
    v_add_u32 v26, s74, v26
    v_add_u32 v27, s74, v27
    s_barrier
    v_mfma_f32_32x32x16_bf16 v[64:79], a[228:231], v[116:119], v[64:79]
    ds_read_b128 a[192:195], v16 offset:0
    ds_read_b128 a[196:199], v17 offset:0
    v_exp_f32 v240, v48
    v_exp_f32 v241, v49
    v_mfma_f32_32x32x16_bf16 v[192:207], a[164:167], v[104:107], v[192:207]
    ds_read_b128 a[200:203], v18 offset:0
    ds_read_b128 a[204:207], v19 offset:0
    v_exp_f32 v242, v50
    v_exp_f32 v243, v51
    v_add_f32 v37, v240, v241
    v_mfma_f32_32x32x16_bf16 v[64:79], a[232:235], v[120:123], v[64:79]
    ds_read_b128 a[208:211], v20 offset:0
    ds_read_b128 a[212:215], v21 offset:0
    v_add_f32 v38, v242, v243
    v_cvt_pk_bf16_f32 v96, v240, v241
    v_cvt_pk_bf16_f32 v97, v242, v243
    v_exp_f32 v244, v52
    v_mfma_f32_32x32x16_bf16 v[208:223], a[168:171], v[104:107], v[208:223]
    ds_read_b128 a[216:219], v22 offset:0
    ds_read_b128 a[220:223], v23 offset:0
    v_exp_f32 v245, v53
    v_exp_f32 v246, v54
    v_mfma_f32_32x32x16_bf16 v[64:79], a[236:239], v[124:127], v[64:79]
    ds_read_b64_tr_b16 a[128:129], v24 offset:0
    ds_read_b64_tr_b16 a[130:131], v24 offset:2048
    v_exp_f32 v247, v55
    v_add_f32 v37, v37, v244
    v_add_f32 v38, v38, v246
    v_add_f32 v37, v37, v245
    v_mfma_f32_32x32x16_bf16 v[224:239], a[172:175], v[104:107], v[224:239]
    ds_read_b64_tr_b16 a[132:133], v25 offset:0
    ds_read_b64_tr_b16 a[134:135], v25 offset:2048
    v_add_f32 v38, v38, v247
    v_cvt_pk_bf16_f32 v98, v244, v245
    v_cvt_pk_bf16_f32 v99, v246, v247
    v_exp_f32 v248, v56
    v_mfma_f32_32x32x16_bf16 v[64:79], a[240:243], v[128:131], v[64:79]
    ds_read_b64_tr_b16 a[136:137], v26 offset:0
    ds_read_b64_tr_b16 a[138:139], v26 offset:2048
    v_exp_f32 v249, v57
    v_exp_f32 v250, v58
    v_mfma_f32_32x32x16_bf16 v[176:191], a[176:179], v[108:111], v[176:191]
    ds_read_b64_tr_b16 a[140:141], v27 offset:0
    ds_read_b64_tr_b16 a[142:143], v27 offset:2048
    v_exp_f32 v251, v59
    v_add_f32 v37, v37, v248
    v_add_f32 v38, v38, v250
    v_add_f32 v37, v37, v249
    v_mfma_f32_32x32x16_bf16 v[192:207], a[180:183], v[108:111], v[192:207]
    ds_read_b64_tr_b16 a[144:145], v24 offset:4096
    ds_read_b64_tr_b16 a[146:147], v24 offset:6144
    v_add_f32 v38, v38, v251
    v_cvt_pk_bf16_f32 v100, v248, v249
    v_cvt_pk_bf16_f32 v101, v250, v251
    v_exp_f32 v252, v60
    v_mfma_f32_32x32x16_bf16 v[64:79], a[244:247], v[132:135], v[64:79]
    ds_read_b64_tr_b16 a[148:149], v25 offset:4096
    ds_read_b64_tr_b16 a[150:151], v25 offset:6144
    v_exp_f32 v253, v61
    v_exp_f32 v254, v62
    v_mfma_f32_32x32x16_bf16 v[208:223], a[184:187], v[108:111], v[208:223]
    ds_read_b64_tr_b16 a[152:153], v26 offset:4096
    ds_read_b64_tr_b16 a[154:155], v26 offset:6144
    v_exp_f32 v255, v63
    v_add_f32 v37, v37, v252
    v_add_f32 v38, v38, v254
    v_mfma_f32_32x32x16_bf16 v[224:239], a[188:191], v[108:111], v[224:239]
    ds_read_b64_tr_b16 a[156:157], v27 offset:4096
    ds_read_b64_tr_b16 a[158:159], v27 offset:6144
    v_add_f32 v37, v37, v253
    v_add_f32 v38, v38, v255
    v_cvt_pk_bf16_f32 v102, v252, v253
    v_cvt_pk_bf16_f32 v103, v254, v255
    v_add_f32 v37, v37, v38
    v_cmp_nge_f32 vcc, s76, v37
    s_nop 0
    s_cbranch_vccnz L_slow0a
L_cont0a:
    v_add_f32 v36, v36, v37
    v_mfma_f32_32x32x16_bf16 v[64:79], a[248:251], v[136:139], v[64:79]
    v_mfma_f32_32x32x16_bf16 v[64:79], a[252:255], v[140:143], v[64:79]
    s_waitcnt lgkmcnt(0)
    v_mfma_f32_32x32x16_bf16 v[48:63], a[192:195], v[112:115], v[80:95]
    ds_read_b128 a[224:227], v16 offset:8192
    ds_read_b128 a[228:231], v17 offset:8192
    v_mfma_f32_32x32x16_bf16 v[176:191], a[128:131], v[96:99], v[176:191]
    ds_read_b128 a[232:235], v18 offset:8192
    ds_read_b128 a[236:239], v19 offset:8192
    v_mfma_f32_32x32x16_bf16 v[48:63], a[196:199], v[116:119], v[48:63]
    ds_read_b128 a[240:243], v20 offset:8192
    ds_read_b128 a[244:247], v21 offset:8192
    v_mfma_f32_32x32x16_bf16 v[192:207], a[132:135], v[96:99], v[192:207]
    ds_read_b128 a[248:251], v22 offset:8192
    ds_read_b128 a[252:255], v23 offset:8192
    v_exp_f32 v240, v64
    v_exp_f32 v241, v65
    v_mfma_f32_32x32x16_bf16 v[48:63], a[200:203], v[120:123], v[48:63]
    ds_read_b64_tr_b16 a[160:161], v24 offset:8192
    ds_read_b64_tr_b16 a[162:163], v24 offset:10240
    v_exp_f32 v242, v66
    v_exp_f32 v243, v67
    v_add_f32 v37, v240, v241
    v_mfma_f32_32x32x16_bf16 v[208:223], a[136:139], v[96:99], v[208:223]
    ds_read_b64_tr_b16 a[164:165], v25 offset:8192
    ds_read_b64_tr_b16 a[166:167], v25 offset:10240
    v_add_f32 v38, v242, v243
    v_cvt_pk_bf16_f32 v104, v240, v241
    v_cvt_pk_bf16_f32 v105, v242, v243
    v_exp_f32 v244, v68
    v_mfma_f32_32x32x16_bf16 v[48:63], a[204:207], v[124:127], v[48:63]
    ds_read_b64_tr_b16 a[168:169], v26 offset:8192
    ds_read_b64_tr_b16 a[170:171], v26 offset:10240
    v_exp_f32 v245, v69
    v_exp_f32 v246, v70
    v_mfma_f32_32x32x16_bf16 v[224:239], a[140:143], v[96:99], v[224:239]
    ds_read_b64_tr_b16 a[172:173], v27 offset:8192
    ds_read_b64_tr_b16 a[174:175], v27 offset:10240
    v_exp_f32 v247, v71
    v_add_f32 v37, v37, v244
    v_add_f32 v38, v38, v246
    v_add_f32 v37, v37, v245
    v_mfma_f32_32x32x16_bf16 v[48:63], a[208:211], v[128:131], v[48:63]
    ds_read_b64_tr_b16 a[176:177], v24 offset:12288
    ds_read_b64_tr_b16 a[178:179], v24 offset:14336
    v_add_f32 v38, v38, v247
    v_cvt_pk_bf16_f32 v106, v244, v245
    v_cvt_pk_bf16_f32 v107, v246, v247
    v_exp_f32 v248, v72
    v_mfma_f32_32x32x16_bf16 v[176:191], a[144:147], v[100:103], v[176:191]
    ds_read_b64_tr_b16 a[180:181], v25 offset:12288
    ds_read_b64_tr_b16 a[182:183], v25 offset:14336
    v_exp_f32 v249, v73
    v_exp_f32 v250, v74
    v_mfma_f32_32x32x16_bf16 v[192:207], a[148:151], v[100:103], v[192:207]
    ds_read_b64_tr_b16 a[184:185], v26 offset:12288
    ds_read_b64_tr_b16 a[186:187], v26 offset:14336
    v_exp_f32 v251, v75
    v_add_f32 v37, v37, v248
    v_add_f32 v38, v38, v250
    v_add_f32 v37, v37, v249
    v_mfma_f32_32x32x16_bf16 v[48:63], a[212:215], v[132:135], v[48:63]
    ds_read_b64_tr_b16 a[188:189], v27 offset:12288
    ds_read_b64_tr_b16 a[190:191], v27 offset:14336
    v_add_f32 v38, v38, v251
    v_cvt_pk_bf16_f32 v108, v248, v249
    v_cvt_pk_bf16_f32 v109, v250, v251
    v_exp_f32 v252, v76
    v_mfma_f32_32x32x16_bf16 v[208:223], a[152:155], v[100:103], v[208:223]
    v_exp_f32 v253, v77
    v_exp_f32 v254, v78
    v_exp_f32 v255, v79
    v_mfma_f32_32x32x16_bf16 v[224:239], a[156:159], v[100:103], v[224:239]
    v_add_f32 v37, v37, v252
    v_add_f32 v38, v38, v254
    v_add_f32 v37, v37, v253
    v_add_f32 v38, v38, v255
    v_cvt_pk_bf16_f32 v110, v252, v253
    v_cvt_pk_bf16_f32 v111, v254, v255
    v_add_f32 v37, v37, v38
    v_cmp_nge_f32 vcc, s76, v37
    s_nop 0
    s_cbranch_vccnz L_slow1a
L_cont1a:
    v_add_f32 v36, v36, v37
    v_mfma_f32_32x32x16_bf16 v[48:63], a[216:219], v[136:139], v[48:63]
    s_add_u32 s81, s81, 1
    s_cmp_eq_u32 s81, 3
    s_cselect_b32 s81, 0, s81
    s_mov_b32 s36, 32768
    s_cmp_eq_u32 s81, 0
    s_cselect_b32 s74, 4294901760, s36
    ds_read_b128 v[8:11], v32
    ds_read_b64_tr_b16 a[64:65], v28 offset:0
    ds_read_b64_tr_b16 a[66:67], v28 offset:1024
    ds_read_b64_tr_b16 a[68:69], v29 offset:0
    v_mfma_f32_32x32x16_bf16 v[48:63], a[220:223], v[140:143], v[48:63]
    ds_read_b64_tr_b16 a[70:71], v29 offset:1024
    ds_read_b64_tr_b16 a[72:73], v30 offset:0
    ds_read_b64_tr_b16 a[74:75], v30 offset:1024
    ds_read_b64_tr_b16 a[76:77], v31 offset:0
    ds_read_b64_tr_b16 a[78:79], v31 offset:1024
    s_waitcnt lgkmcnt(0)
    v_mfma_f32_32x32x16_bf16 a[0:15], a[64:67], v[8:11], a[0:15]
    ds_read_b128 v[12:15], v33
    ds_read_b64_tr_b16 a[80:81], v28 offset:4096
    ds_read_b64_tr_b16 a[82:83], v28 offset:5120
    v_mfma_f32_32x32x16_bf16 a[16:31], a[68:71], v[8:11], a[16:31]
    ds_read_b64_tr_b16 a[84:85], v29 offset:4096
    ds_read_b64_tr_b16 a[86:87], v29 offset:5120
    ds_read_b64_tr_b16 a[88:89], v30 offset:4096
    v_mfma_f32_32x32x16_bf16 a[32:47], a[72:75], v[8:11], a[32:47]
    ds_read_b64_tr_b16 a[90:91], v30 offset:5120
    ds_read_b64_tr_b16 a[92:93], v31 offset:4096
    ds_read_b64_tr_b16 a[94:95], v31 offset:5120
    v_mfma_f32_32x32x16_bf16 a[48:63], a[76:79], v[8:11], a[48:63]
    s_waitcnt lgkmcnt(0)
    v_mfma_f32_32x32x16_bf16 a[0:15], a[80:83], v[12:15], a[0:15]
    ds_read_b128 v[8:11], v34
    ds_read_b64_tr_b16 a[64:65], v28 offset:8192
    ds_read_b64_tr_b16 a[66:67], v28 offset:9216
    v_mfma_f32_32x32x16_bf16 a[16:31], a[84:87], v[12:15], a[16:31]
    ds_read_b64_tr_b16 a[68:69], v29 offset:8192
    ds_read_b64_tr_b16 a[70:71], v29 offset:9216
    ds_read_b64_tr_b16 a[72:73], v30 offset:8192
    v_mfma_f32_32x32x16_bf16 a[32:47], a[88:91], v[12:15], a[32:47]
    ds_read_b64_tr_b16 a[74:75], v30 offset:9216
    ds_read_b64_tr_b16 a[76:77], v31 offset:8192
    ds_read_b64_tr_b16 a[78:79], v31 offset:9216
    v_mfma_f32_32x32x16_bf16 a[48:63], a[92:95], v[12:15], a[48:63]
    s_waitcnt lgkmcnt(0)
    v_mfma_f32_32x32x16_bf16 a[0:15], a[64:67], v[8:11], a[0:15]
    ds_read_b128 v[12:15], v35
    ds_read_b64_tr_b16 a[80:81], v28 offset:12288
    ds_read_b64_tr_b16 a[82:83], v28 offset:13312
    v_mfma_f32_32x32x16_bf16 a[16:31], a[68:71], v[8:11], a[16:31]
    ds_read_b64_tr_b16 a[84:85], v29 offset:12288
    ds_read_b64_tr_b16 a[86:87], v29 offset:13312
    ds_read_b64_tr_b16 a[88:89], v30 offset:12288
    v_mfma_f32_32x32x16_bf16 a[32:47], a[72:75], v[8:11], a[32:47]
    ds_read_b64_tr_b16 a[90:91], v30 offset:13312
    ds_read_b64_tr_b16 a[92:93], v31 offset:12288
    ds_read_b64_tr_b16 a[94:95], v31 offset:13312
    v_mfma_f32_32x32x16_bf16 a[48:63], a[76:79], v[8:11], a[48:63]
    s_waitcnt lgkmcnt(0)
    v_mfma_f32_32x32x16_bf16 a[0:15], a[80:83], v[12:15], a[0:15]
    v_add_u32 v28, s83, v28
    v_add_u32 v29, s83, v29
    v_add_u32 v30, s83, v30
    v_add_u32 v31, s83, v31
    v_mfma_f32_32x32x16_bf16 a[16:31], a[84:87], v[12:15], a[16:31]
    v_add_u32 v32, s83, v32
    v_add_u32 v33, s83, v33
    v_add_u32 v34, s83, v34
    v_add_u32 v35, s83, v35
    v_mfma_f32_32x32x16_bf16 a[32:47], a[88:91], v[12:15], a[32:47]
    s_sub_u32 s83, 0, s83
    s_sub_u32 s75, s75, 1
    s_cmp_lg_u32 s75, 0
    v_mfma_f32_32x32x16_bf16 a[48:63], a[92:95], v[12:15], a[48:63]
    s_cbranch_scc1 L_attn_q2
    s_setpc_b64 s[66:67]
L_attn_oa:
    s_waitcnt lgkmcnt(0)
    v_mfma_f32_32x32x16_bf16 v[64:79], a[224:227], v[112:115], v[80:95]
    v_add_u32 v16, s74, v16
    v_add_u32 v17, s74, v17
    v_add_u32 v18, s74, v18
    v_add_u32 v19, s74, v19
    v_add_u32 v20, s74, v20
    v_add_u32 v21, s74, v21
    v_mfma_f32_32x32x16_bf16 v[176:191], a[160:163], v[104:107], v[176:191]
    v_add_u32 v22, s74, v22
    v_add_u32 v23, s74, v23
    v_add_u32 v24, s74, v24
    v_add_u32 v25, s74, v25
    v_add_u32 v26, s74, v26
    v_add_u32 v27, s74, v27
    s_barrier
    v_mfma_f32_32x32x16_bf16 v[64:79], a[228:231], v[116:119], v[64:79]
    ds_read_b128 a[192:195], v16 offset:0
    ds_read_b128 a[196:199], v17 offset:0
    v_exp_f32 v240, v48
    v_exp_f32 v241, v49
    v_mfma_f32_32x32x16_bf16 v[192:207], a[164:167], v[104:107], v[192:207]
    ds_read_b128 a[200:203], v18 offset:0
    ds_read_b128 a[204:207], v19 offset:0
    v_exp_f32 v242, v50
    v_exp_f32 v243, v51
    v_add_f32 v37, v240, v241
    v_mfma_f32_32x32x16_bf16 v[64:79], a[232:235], v[120:123], v[64:79]
    ds_read_b128 a[208:211], v20 offset:0
    ds_read_b128 a[212:215], v21 offset:0
    v_add_f32 v38, v242, v243
    v_cvt_pk_bf16_f32 v96, v240, v241
    v_cvt_pk_bf16_f32 v97, v242, v243
    v_exp_f32 v244, v52
    v_mfma_f32_32x32x16_bf16 v[208:223], a[168:171], v[104:107], v[208:223]
    ds_read_b128 a[216:219], v22 offset:0
    ds_read_b128 a[220:223], v23 offset:0
    v_exp_f32 v245, v53
    v_exp_f32 v246, v54
    v_mfma_f32_32x32x16_bf16 v[64:79], a[236:239], v[124:127], v[64:79]
    ds_read_b64_tr_b16 a[128:129], v24 offset:0
    ds_read_b64_tr_b16 a[130:131], v24 offset:2048
    v_exp_f32 v247, v55
    v_add_f32 v37, v37, v244
    v_add_f32 v38, v38, v246
    v_add_f32 v37, v37, v245
    v_mfma_f32_32x32x16_bf16 v[224:239], a[172:175], v[104:107], v[224:239]
    ds_read_b64_tr_b16 a[132:133], v25 offset:0
    ds_read_b64_tr_b16 a[134:135], v25 offset:2048
    v_add_f32 v38, v38, v247
    v_cvt_pk_bf16_f32 v98, v244, v245
    v_cvt_pk_bf16_f32 v99, v246, v247
    v_exp_f32 v248, v56
    v_mfma_f32_32x32x16_bf16 v[64:79], a[240:243], v[128:131], v[64:79]
    ds_read_b64_tr_b16 a[136:137], v26 offset:0
    ds_read_b64_tr_b16 a[138:139], v26 offset:2048
    v_exp_f32 v249, v57
    v_exp_f32 v250, v58
    v_mfma_f32_32x32x16_bf16 v[176:191], a[176:179], v[108:111], v[176:191]
    ds_read_b64_tr_b16 a[140:141], v27 offset:0
    ds_read_b64_tr_b16 a[142:143], v27 offset:2048
    v_exp_f32 v251, v59
    v_add_f32 v37, v37, v248
    v_add_f32 v38, v38, v250
    v_add_f32 v37, v37, v249
    v_mfma_f32_32x32x16_bf16 v[192:207], a[180:183], v[108:111], v[192:207]
    ds_read_b64_tr_b16 a[144:145], v24 offset:4096
    ds_read_b64_tr_b16 a[146:147], v24 offset:6144
    v_add_f32 v38, v38, v251
    v_cvt_pk_bf16_f32 v100, v248, v249
    v_cvt_pk_bf16_f32 v101, v250, v251
    v_exp_f32 v252, v60
    v_mfma_f32_32x32x16_bf16 v[64:79], a[244:247], v[132:135], v[64:79]
    ds_read_b64_tr_b16 a[148:149], v25 offset:4096
    ds_read_b64_tr_b16 a[150:151], v25 offset:6144
    v_exp_f32 v253, v61
    v_exp_f32 v254, v62
    v_mfma_f32_32x32x16_bf16 v[208:223], a[184:187], v[108:111], v[208:223]
    ds_read_b64_tr_b16 a[152:153], v26 offset:4096
    ds_read_b64_tr_b16 a[154:155], v26 offset:6144
    v_exp_f32 v255, v63
    v_add_f32 v37, v37, v252
    v_add_f32 v38, v38, v254
    v_mfma_f32_32x32x16_bf16 v[224:239], a[188:191], v[108:111], v[224:239]
    ds_read_b64_tr_b16 a[156:157], v27 offset:4096
    ds_read_b64_tr_b16 a[158:159], v27 offset:6144
    v_add_f32 v37, v37, v253
    v_add_f32 v38, v38, v255
    v_cvt_pk_bf16_f32 v102, v252, v253
    v_cvt_pk_bf16_f32 v103, v254, v255
    v_add_f32 v37, v37, v38
    v_cmp_nge_f32 vcc, s76, v37
    s_nop 0
    s_cbranch_vccnz L_slow0b
L_cont0b:
    v_add_f32 v36, v36, v37
    v_mfma_f32_32x32x16_bf16 v[64:79], a[248:251], v[136:139], v[64:79]
    v_mfma_f32_32x32x16_bf16 v[64:79], a[252:255], v[140:143], v[64:79]
    s_waitcnt lgkmcnt(0)
    v_mfma_f32_32x32x16_bf16 v[48:63], a[192:195], v[112:115], v[80:95]
    ds_read_b128 a[224:227], v16 offset:8192
    ds_read_b128 a[228:231], v17 offset:8192
    v_mfma_f32_32x32x16_bf16 v[176:191], a[128:131], v[96:99], v[176:191]
    ds_read_b128 a[232:235], v18 offset:8192
    ds_read_b128 a[236:239], v19 offset:8192
    v_mfma_f32_32x32x16_bf16 v[48:63], a[196:199], v[116:119], v[48:63]
    ds_read_b128 a[240:243], v20 offset:8192
    ds_read_b128 a[244:247], v21 offset:8192
    v_mfma_f32_32x32x16_bf16 v[192:207], a[132:135], v[96:99], v[192:207]
    ds_read_b128 a[248:251], v22 offset:8192
    ds_read_b128 a[252:255], v23 offset:8192
    v_exp_f32 v240, v64
    v_exp_f32 v241, v65
    v_mfma_f32_32x32x16_bf16 v[48:63], a[200:203], v[120:123], v[48:63]
    ds_read_b64_tr_b16 a[160:161], v24 offset:8192
    ds_read_b64_tr_b16 a[162:163], v24 offset:10240
    v_exp_f32 v242, v66
    v_exp_f32 v243, v67
    v_add_f32 v37, v240, v241
    v_mfma_f32_32x32x16_bf16 v[208:223], a[136:139], v[96:99], v[208:223]
    ds_read_b64_tr_b16 a[164:165], v25 offset:8192
    ds_read_b64_tr_b16 a[166:167], v25 offset:10240
    v_add_f32 v38, v242, v243
    v_cvt_pk_bf16_f32 v104, v240, v241
    v_cvt_pk_bf16_f32 v105, v242, v243
    v_exp_f32 v244, v68
    v_mfma_f32_32x32x16_bf16 v[48:63], a[204:207], v[124:127], v[48:63]
    ds_read_b64_tr_b16 a[168:169], v26 offset:8192
    ds_read_b64_tr_b16 a[170:171], v26 offset:10240
    v_exp_f32 v245, v69
    v_exp_f32 v246, v70
    v_mfma_f32_32x32x16_bf16 v[224:239], a[140:143], v[96:99], v[224:239]
    ds_read_b64_tr_b16 a[172:173], v27 offset:8192
    ds_read_b64_tr_b16 a[174:175], v27 offset:10240
    v_exp_f32 v247, v71
    v_add_f32 v37, v37, v244
    v_add_f32 v38, v38, v246
    v_add_f32 v37, v37, v245
    v_mfma_f32_32x32x16_bf16 v[48:63], a[208:211], v[128:131], v[48:63]
    ds_read_b64_tr_b16 a[176:177], v24 offset:12288
    ds_read_b64_tr_b16 a[178:179], v24 offset:14336
    v_add_f32 v38, v38, v247
    v_cvt_pk_bf16_f32 v106, v244, v245
    v_cvt_pk_bf16_f32 v107, v246, v247
    v_exp_f32 v248, v72
    v_mfma_f32_32x32x16_bf16 v[176:191], a[144:147], v[100:103], v[176:191]
    ds_read_b64_tr_b16 a[180:181], v25 offset:12288
    ds_read_b64_tr_b16 a[182:183], v25 offset:14336
    v_exp_f32 v249, v73
    v_exp_f32 v250, v74
    v_mfma_f32_32x32x16_bf16 v[192:207], a[148:151], v[100:103], v[192:207]
    ds_read_b64_tr_b16 a[184:185], v26 offset:12288
    ds_read_b64_tr_b16 a[186:187], v26 offset:14336
    v_exp_f32 v251, v75
    v_add_f32 v37, v37, v248
    v_add_f32 v38, v38, v250
    v_add_f32 v37, v37, v249
    v_mfma_f32_32x32x16_bf16 v[48:63], a[212:215], v[132:135], v[48:63]
    ds_read_b64_tr_b16 a[188:189], v27 offset:12288
    ds_read_b64_tr_b16 a[190:191], v27 offset:14336
    v_add_f32 v38, v38, v251
    v_cvt_pk_bf16_f32 v108, v248, v249
    v_cvt_pk_bf16_f32 v109, v250, v251
    v_exp_f32 v252, v76
    v_mfma_f32_32x32x16_bf16 v[208:223], a[152:155], v[100:103], v[208:223]
    v_exp_f32 v253, v77
    v_exp_f32 v254, v78
    v_exp_f32 v255, v79
    v_mfma_f32_32x32x16_bf16 v[224:239], a[156:159], v[100:103], v[224:239]
    v_add_f32 v37, v37, v252
    v_add_f32 v38, v38, v254
    v_add_f32 v37, v37, v253
    v_add_f32 v38, v38, v255
    v_cvt_pk_bf16_f32 v110, v252, v253
    v_cvt_pk_bf16_f32 v111, v254, v255
    v_add_f32 v37, v37, v38
    v_cmp_nge_f32 vcc, s76, v37
    s_nop 0
    s_cbranch_vccnz L_slow1b
L_cont1b:
    v_add_f32 v36, v36, v37
    v_mfma_f32_32x32x16_bf16 v[48:63], a[216:219], v[136:139], v[48:63]
    s_add_u32 s81, s81, 1
    s_cmp_eq_u32 s81, 3
    s_cselect_b32 s81, 0, s81
    s_mov_b32 s36, 32768
    s_cmp_eq_u32 s81, 0
    s_cselect_b32 s74, 4294901760, s36
    v_add_u32 v4, s83, v40
    v_add_u32 v5, s83, v41
    ds_read_b128 v[8:11], v5 offset:0
    ds_read_b64_tr_b16 a[80:81], v4 offset:0
    ds_read_b64_tr_b16 a[82:83], v4 offset:1280
    ds_read_b64_tr_b16 a[84:85], v4 offset:64
    v_mfma_f32_32x32x16_bf16 v[48:63], a[220:223], v[140:143], v[48:63]
    ds_read_b64_tr_b16 a[86:87], v4 offset:1344
    ds_read_b64_tr_b16 a[88:89], v4 offset:128
    ds_read_b64_tr_b16 a[90:91], v4 offset:1408
    ds_read_b64_tr_b16 a[92:93], v4 offset:192
    ds_read_b64_tr_b16 a[94:95], v4 offset:1472
    ds_read_b64_tr_b16 a[96:97], v4 offset:256
    ds_read_b64_tr_b16 a[98:99], v4 offset:1536
    s_waitcnt lgkmcnt(0)
    v_mfma_f32_32x32x16_bf16 a[0:15], a[80:83], v[8:11], a[0:15]
    ds_read_b128 v[12:15], v5 offset:1024
    ds_read_b64_tr_b16 a[100:101], v4 offset:5120
    ds_read_b64_tr_b16 a[102:103], v4 offset:6400
    v_mfma_f32_32x32x16_bf16 a[16:31], a[84:87], v[8:11], a[16:31]
    ds_read_b64_tr_b16 a[104:105], v4 offset:5184
    ds_read_b64_tr_b16 a[106:107], v4 offset:6464
    ds_read_b64_tr_b16 a[108:109], v4 offset:5248
    v_mfma_f32_32x32x16_bf16 a[32:47], a[88:91], v[8:11], a[32:47]
    ds_read_b64_tr_b16 a[110:111], v4 offset:6528
    ds_read_b64_tr_b16 a[112:113], v4 offset:5312
    ds_read_b64_tr_b16 a[114:115], v4 offset:6592
    v_mfma_f32_32x32x16_bf16 a[48:63], a[92:95], v[8:11], a[48:63]
    ds_read_b64_tr_b16 a[116:117], v4 offset:5376
    ds_read_b64_tr_b16 a[118:119], v4 offset:6656
    v_mfma_f32_32x32x16_bf16 a[64:79], a[96:99], v[8:11], a[64:79]
    s_waitcnt lgkmcnt(0)
    v_mfma_f32_32x32x16_bf16 a[0:15], a[100:103], v[12:15], a[0:15]
    ds_read_b128 v[8:11], v5 offset:2048
    ds_read_b64_tr_b16 a[80:81], v4 offset:10240
    ds_read_b64_tr_b16 a[82:83], v4 offset:11520
    v_mfma_f32_32x32x16_bf16 a[16:31], a[104:107], v[12:15], a[16:31]
    ds_read_b64_tr_b16 a[84:85], v4 offset:10304
    ds_read_b64_tr_b16 a[86:87], v4 offset:11584
    ds_read_b64_tr_b16 a[88:89], v4 offset:10368
    v_mfma_f32_32x32x16_bf16 a[32:47], a[108:111], v[12:15], a[32:47]
    ds_read_b64_tr_b16 a[90:91], v4 offset:11648
    ds_read_b64_tr_b16 a[92:93], v4 offset:10432
    ds_read_b64_tr_b16 a[94:95], v4 offset:11712
    v_mfma_f32_32x32x16_bf16 a[48:63], a[112:115], v[12:15], a[48:63]
    ds_read_b64_tr_b16 a[96:97], v4 offset:10496
    ds_read_b64_tr_b16 a[98:99], v4 offset:11776
    v_mfma_f32_32x32x16_bf16 a[64:79], a[116:119], v[12:15], a[64:79]
    s_waitcnt lgkmcnt(0)
    v_mfma_f32_32x32x16_bf16 a[0:15], a[80:83], v[8:11], a[0:15]
    ds_read_b128 v[12:15], v5 offset:3072
    ds_read_b64_tr_b16 a[100:101], v4 offset:15360
    ds_read_b64_tr_b16 a[102:103], v4 offset:16640
    v_mfma_f32_32x32x16_bf16 a[16:31], a[84:87], v[8:11], a[16:31]
    ds_read_b64_tr_b16 a[104:105], v4 offset:15424
    ds_read_b64_tr_b16 a[106:107], v4 offset:16704
    ds_read_b64_tr_b16 a[108:109], v4 offset:15488
    v_mfma_f32_32x32x16_bf16 a[32:47], a[88:91], v[8:11], a[32:47]
    ds_read_b64_tr_b16 a[110:111], v4 offset:16768
    ds_read_b64_tr_b16 a[112:113], v4 offset:15552
    ds_read_b64_tr_b16 a[114:115], v4 offset:16832
    v_mfma_f32_32x32x16_bf16 a[48:63], a[92:95], v[8:11], a[48:63]
    ds_read_b64_tr_b16 a[116:117], v4 offset:15616
    ds_read_b64_tr_b16 a[118:119], v4 offset:16896
    v_mfma_f32_32x32x16_bf16 a[64:79], a[96:99], v[8:11], a[64:79]
    s_waitcnt lgkmcnt(0)
    v_mfma_f32_32x32x16_bf16 a[0:15], a[100:103], v[12:15], a[0:15]
    s_xor_b32 s83, s83, 229376
    s_sub_u32 s75, s75, 1
    s_cmp_lg_u32 s75, 0
    v_mfma_f32_32x32x16_bf16 a[16:31], a[104:107], v[12:15], a[16:31]
    v_mfma_f32_32x32x16_bf16 a[32:47], a[108:111], v[12:15], a[32:47]
    v_mfma_f32_32x32x16_bf16 a[48:63], a[112:115], v[12:15], a[48:63]
    v_mfma_f32_32x32x16_bf16 a[64:79], a[116:119], v[12:15], a[64:79]
    s_cbranch_scc1 L_attn_oa
    s_setpc_b64 s[66:67]
L_uepi:
    v_mfma_f32_32x32x16_bf16 v[176:191], a[160:163], v[104:107], v[176:191]
    v_mov_b32 v2, v36
    v_mov_b32 v3, v36
    v_mfma_f32_32x32x16_bf16 v[192:207], a[164:167], v[104:107], v[192:207]
    s_lshl_b32 s36, s32, 3
    s_add_u32 s36, s36, s34
    v_mfma_f32_32x32x16_bf16 v[208:223], a[168:171], v[104:107], v[208:223]
    v_permlane32_swap_b32 v2, v3
    s_lshl_b32 s36, s36, 5
    v_mfma_f32_32x32x16_bf16 v[224:239], a[172:175], v[104:107], v[224:239]
    v_add_f32 v2, v2, v3
    s_add_u32 s36, s36, s70
    v_mfma_f32_32x32x16_bf16 v[176:191], a[176:179], v[108:111], v[176:191]
    v_rcp_f32 v2, v2
    s_mul_i32 s36, s36, 3
    v_mfma_f32_32x32x16_bf16 v[192:207], a[180:183], v[108:111], v[192:207]
    s_add_u32 s36, s36, s3
    v_mov_b32 v3, v2
    v_mfma_f32_32x32x16_bf16 v[208:223], a[184:187], v[108:111], v[208:223]
    s_lshl_b32 s36, s36, 13
    v_mfma_f32_32x32x16_bf16 v[224:239], a[188:191], v[108:111], v[224:239]
    s_nop 7
    s_nop 3
    v_pk_mul_f32 v[176:177], v[176:177], v[2:3]
    v_pk_mul_f32 v[178:179], v[178:179], v[2:3]
    v_pk_mul_f32 v[180:181], v[180:181], v[2:3]
    v_pk_mul_f32 v[182:183], v[182:183], v[2:3]
    v_cvt_pk_bf16_f32 v144, v176, v177
    v_cvt_pk_bf16_f32 v145, v178, v179
    v_cvt_pk_bf16_f32 v146, v180, v181
    v_cvt_pk_bf16_f32 v147, v182, v183
    buffer_store_dwordx4 v[144:147], v42, s[24:27], s36 offen offset:0 sc1
    v_pk_mul_f32 v[184:185], v[184:185], v[2:3]
    v_pk_mul_f32 v[186:187], v[186:187], v[2:3]
    v_pk_mul_f32 v[188:189], v[188:189], v[2:3]
    v_pk_mul_f32 v[190:191], v[190:191], v[2:3]
    v_cvt_pk_bf16_f32 v148, v184, v185
    v_cvt_pk_bf16_f32 v149, v186, v187
    v_cvt_pk_bf16_f32 v150, v188, v189
    v_cvt_pk_bf16_f32 v151, v190, v191
    buffer_store_dwordx4 v[148:151], v42, s[24:27], s36 offen offset:1024 sc1
    v_pk_mul_f32 v[192:193], v[192:193], v[2:3]
    v_pk_mul_f32 v[194:195], v[194:195], v[2:3]
    v_pk_mul_f32 v[196:197], v[196:197], v[2:3]
    v_pk_mul_f32 v[198:199], v[198:199], v[2:3]
    v_cvt_pk_bf16_f32 v152, v192, v193
    v_cvt_pk_bf16_f32 v153, v194, v195
    v_cvt_pk_bf16_f32 v154, v196, v197
    v_cvt_pk_bf16_f32 v155, v198, v199
    buffer_store_dwordx4 v[152:155], v42, s[24:27], s36 offen offset:2048 sc1
    v_pk_mul_f32 v[200:201], v[200:201], v[2:3]
    v_pk_mul_f32 v[202:203], v[202:203], v[2:3]
    v_pk_mul_f32 v[204:205], v[204:205], v[2:3]
    v_pk_mul_f32 v[206:207], v[206:207], v[2:3]
    v_cvt_pk_bf16_f32 v156, v200, v201
    v_cvt_pk_bf16_f32 v157, v202, v203
    v_cvt_pk_bf16_f32 v158, v204, v205
    v_cvt_pk_bf16_f32 v159, v206, v207
    buffer_store_dwordx4 v[156:159], v42, s[24:27], s36 offen offset:3072 sc1
    s_add_u32 s36, s36, 4096
    v_pk_mul_f32 v[208:209], v[208:209], v[2:3]
    v_pk_mul_f32 v[210:211], v[210:211], v[2:3]
    v_pk_mul_f32 v[212:213], v[212:213], v[2:3]
    v_pk_mul_f32 v[214:215], v[214:215], v[2:3]
    v_cvt_pk_bf16_f32 v160, v208, v209
    v_cvt_pk_bf16_f32 v161, v210, v211
    v_cvt_pk_bf16_f32 v162, v212, v213
    v_cvt_pk_bf16_f32 v163, v214, v215
    buffer_store_dwordx4 v[160:163], v42, s[24:27], s36 offen offset:0 sc1
    v_pk_mul_f32 v[216:217], v[216:217], v[2:3]
    v_pk_mul_f32 v[218:219], v[218:219], v[2:3]
    v_pk_mul_f32 v[220:221], v[220:221], v[2:3]
    v_pk_mul_f32 v[222:223], v[222:223], v[2:3]
    v_cvt_pk_bf16_f32 v164, v216, v217
    v_cvt_pk_bf16_f32 v165, v218, v219
    v_cvt_pk_bf16_f32 v166, v220, v221
    v_cvt_pk_bf16_f32 v167, v222, v223
    buffer_store_dwordx4 v[164:167], v42, s[24:27], s36 offen offset:1024 sc1
    v_pk_mul_f32 v[224:225], v[224:225], v[2:3]
    v_pk_mul_f32 v[226:227], v[226:227], v[2:3]
    v_pk_mul_f32 v[228:229], v[228:229], v[2:3]
    v_pk_mul_f32 v[230:231], v[230:231], v[2:3]
    v_cvt_pk_bf16_f32 v168, v224, v225
    v_cvt_pk_bf16_f32 v169, v226, v227
    v_cvt_pk_bf16_f32 v170, v228, v229
    v_cvt_pk_bf16_f32 v171, v230, v231
    buffer_store_dwordx4 v[168:171], v42, s[24:27], s36 offen offset:2048 sc1
    v_pk_mul_f32 v[232:233], v[232:233], v[2:3]
    v_pk_mul_f32 v[234:235], v[234:235], v[2:3]
    v_pk_mul_f32 v[236:237], v[236:237], v[2:3]
    v_pk_mul_f32 v[238:239], v[238:239], v[2:3]
    v_cvt_pk_bf16_f32 v172, v232, v233
    v_cvt_pk_bf16_f32 v173, v234, v235
    v_cvt_pk_bf16_f32 v174, v236, v237
    v_cvt_pk_bf16_f32 v175, v238, v239
    buffer_store_dwordx4 v[172:175], v42, s[24:27], s36 offen offset:3072 sc1
    s_add_u32 s36, s36, 4096
    s_setpc_b64 s[66:67]
L_own:
    s_waitcnt lgkmcnt(0)
    v_mfma_f32_32x32x16_bf16 a[0:15], a[80:83], v[144:147], a[0:15]
    ds_read_b64_tr_b16 v[176:177], v4 offset:10240
    ds_read_b64_tr_b16 v[178:179], v4 offset:11520
    ds_read_b64_tr_b16 v[180:181], v4 offset:10304
    v_mfma_f32_32x32x16_bf16 a[16:31], a[84:87], v[144:147], a[16:31]
    ds_read_b64_tr_b16 v[182:183], v4 offset:11584
    ds_read_b64_tr_b16 v[184:185], v4 offset:10368
    ds_read_b64_tr_b16 v[186:187], v4 offset:11648
    v_mfma_f32_32x32x16_bf16 a[32:47], a[88:91], v[144:147], a[32:47]
    ds_read_b64_tr_b16 v[188:189], v4 offset:10432
    ds_read_b64_tr_b16 v[190:191], v4 offset:11712
    ds_read_b64_tr_b16 v[192:193], v4 offset:10496
    v_mfma_f32_32x32x16_bf16 a[48:63], a[92:95], v[144:147], a[48:63]
    ds_read_b64_tr_b16 v[194:195], v4 offset:11776
    v_mfma_f32_32x32x16_bf16 a[64:79], a[96:99], v[144:147], a[64:79]
L_own_k1:
    s_waitcnt lgkmcnt(10)
    v_mfma_f32_32x32x16_bf16 a[0:15], a[100:103], v[148:151], a[0:15]
    ds_read_b64_tr_b16 a[80:81], v4 offset:15360
    ds_read_b64_tr_b16 a[82:83], v4 offset:16640
    ds_read_b64_tr_b16 a[84:85], v4 offset:15424
    v_mfma_f32_32x32x16_bf16 a[16:31], a[104:107], v[148:151], a[16:31]
    ds_read_b64_tr_b16 a[86:87], v4 offset:16704
    ds_read_b64_tr_b16 a[88:89], v4 offset:15488
    ds_read_b64_tr_b16 a[90:91], v4 offset:16768
    v_mfma_f32_32x32x16_bf16 a[32:47], a[108:111], v[148:151], a[32:47]
    ds_read_b64_tr_b16 a[92:93], v4 offset:15552
    ds_read_b64_tr_b16 a[94:95], v4 offset:16832
    ds_read_b64_tr_b16 a[96:97], v4 offset:15616
    v_mfma_f32_32x32x16_bf16 a[48:63], a[112:115], v[148:151], a[48:63]
    ds_read_b64_tr_b16 a[98:99], v4 offset:16896
    v_mfma_f32_32x32x16_bf16 a[64:79], a[116:119], v[148:151], a[64:79]
    s_waitcnt lgkmcnt(10)
    v_mfma_f32_32x32x16_bf16 a[0:15], v[176:179], v[152:155], a[0:15]
    ds_read_b64_tr_b16 a[100:101], v5 offset:0
    ds_read_b64_tr_b16 a[102:103], v5 offset:1280
    ds_read_b64_tr_b16 a[104:105], v5 offset:64
    v_mfma_f32_32x32x16_bf16 a[16:31], v[180:183], v[152:155], a[16:31]
    ds_read_b64_tr_b16 a[106:107], v5 offset:1344
    ds_read_b64_tr_b16 a[108:109], v5 offset:128
    ds_read_b64_tr_b16 a[110:111], v5 offset:1408
    v_mfma_f32_32x32x16_bf16 a[32:47], v[184:187], v[152:155], a[32:47]
    ds_read_b64_tr_b16 a[112:113], v5 offset:192
    ds_read_b64_tr_b16 a[114:115], v5 offset:1472
    ds_read_b64_tr_b16 a[116:117], v5 offset:256
    v_mfma_f32_32x32x16_bf16 a[48:63], v[188:191], v[152:155], a[48:63]
    ds_read_b64_tr_b16 a[118:119], v5 offset:1536
    v_mfma_f32_32x32x16_bf16 a[64:79], v[192:195], v[152:155], a[64:79]
    s_waitcnt lgkmcnt(10)
    v_mfma_f32_32x32x16_bf16 a[0:15], a[80:83], v[156:159], a[0:15]
    ds_read_b64_tr_b16 v[176:177], v5 offset:5120
    ds_read_b64_tr_b16 v[178:179], v5 offset:6400
    ds_read_b64_tr_b16 v[180:181], v5 offset:5184
    v_mfma_f32_32x32x16_bf16 a[16:31], a[84:87], v[156:159], a[16:31]
    ds_read_b64_tr_b16 v[182:183], v5 offset:6464
    ds_read_b64_tr_b16 v[184:185], v5 offset:5248
    ds_read_b64_tr_b16 v[186:187], v5 offset:6528
    v_mfma_f32_32x32x16_bf16 a[32:47], a[88:91], v[156:159], a[32:47]
    ds_read_b64_tr_b16 v[188:189], v5 offset:5312
    ds_read_b64_tr_b16 v[190:191], v5 offset:6592
    ds_read_b64_tr_b16 v[192:193], v5 offset:5376
    v_mfma_f32_32x32x16_bf16 a[48:63], a[92:95], v[156:159], a[48:63]
    ds_read_b64_tr_b16 v[194:195], v5 offset:6656
    v_mfma_f32_32x32x16_bf16 a[64:79], a[96:99], v[156:159], a[64:79]
    s_waitcnt lgkmcnt(10)
    v_mfma_f32_32x32x16_bf16 a[0:15], a[100:103], v[160:163], a[0:15]
    ds_read_b64_tr_b16 a[80:81], v5 offset:10240
    ds_read_b64_tr_b16 a[82:83], v5 offset:11520
    ds_read_b64_tr_b16 a[84:85], v5 offset:10304
    v_mfma_f32_32x32x16_bf16 a[16:31], a[104:107], v[160:163], a[16:31]
    ds_read_b64_tr_b16 a[86:87], v5 offset:11584
    ds_read_b64_tr_b16 a[88:89], v5 offset:10368
    ds_read_b64_tr_b16 a[90:91], v5 offset:11648
    v_mfma_f32_32x32x16_bf16 a[32:47], a[108:111], v[160:163], a[32:47]
    ds_read_b64_tr_b16 a[92:93], v5 offset:10432
    ds_read_b64_tr_b16 a[94:95], v5 offset:11712
    ds_read_b64_tr_b16 a[96:97], v5 offset:10496
    v_mfma_f32_32x32x16_bf16 a[48:63], a[112:115], v[160:163], a[48:63]
    ds_read_b64_tr_b16 a[98:99], v5 offset:11776
    v_mfma_f32_32x32x16_bf16 a[64:79], a[116:119], v[160:163], a[64:79]
    s_waitcnt lgkmcnt(10)
    v_mfma_f32_32x32x16_bf16 a[0:15], v[176:179], v[164:167], a[0:15]
    ds_read_b64_tr_b16 a[100:101], v5 offset:15360
    ds_read_b64_tr_b16 a[102:103], v5 offset:16640
    ds_read_b64_tr_b16 a[104:105], v5 offset:15424
    v_mfma_f32_32x32x16_bf16 a[16:31], v[180:183], v[164:167], a[16:31]
    ds_read_b64_tr_b16 a[106:107], v5 offset:16704
    ds_read_b64_tr_b16 a[108:109], v5 offset:15488
    ds_read_b64_tr_b16 a[110:111], v5 offset:16768
    v_mfma_f32_32x32x16_bf16 a[32:47], v[184:187], v[164:167], a[32:47]
    ds_read_b64_tr_b16 a[112:113], v5 offset:15552
    ds_read_b64_tr_b16 a[114:115], v5 offset:16832
    ds_read_b64_tr_b16 a[116:117], v5 offset:15616
    v_mfma_f32_32x32x16_bf16 a[48:63], v[188:191], v[164:167], a[48:63]
    ds_read_b64_tr_b16 a[118:119], v5 offset:16896
    v_mfma_f32_32x32x16_bf16 a[64:79], v[192:195], v[164:167], a[64:79]
    s_waitcnt vmcnt(0)
    s_lshl_b32 s38, s35, 2
    s_lshl_b32 s39, s3, 4
    s_add_u32 s38, s38, s39
    s_add_u32 s38, s38, s64
    s_add_u32 s38, s38, 16384
    v_mov_b32 v44, s71
    s_mov_b64 exec, 1
    buffer_store_dword v44, v43, s[24:27], s38 offen sc1
    s_mov_b64 exec, -1
    s_waitcnt lgkmcnt(10)
    v_mfma_f32_32x32x16_bf16 a[0:15], a[80:83], v[168:171], a[0:15]
    v_mfma_f32_32x32x16_bf16 a[16:31], a[84:87], v[168:171], a[16:31]
    v_mfma_f32_32x32x16_bf16 a[32:47], a[88:91], v[168:171], a[32:47]
    v_mfma_f32_32x32x16_bf16 a[48:63], a[92:95], v[168:171], a[48:63]
    v_mfma_f32_32x32x16_bf16 a[64:79], a[96:99], v[168:171], a[64:79]
    s_waitcnt lgkmcnt(0)
    v_mfma_f32_32x32x16_bf16 a[0:15], a[100:103], v[172:175], a[0:15]
    v_mfma_f32_32x32x16_bf16 a[16:31], a[104:107], v[172:175], a[16:31]
    v_mfma_f32_32x32x16_bf16 a[32:47], a[108:111], v[172:175], a[32:47]
    v_mfma_f32_32x32x16_bf16 a[48:63], a[112:115], v[172:175], a[48:63]
    v_mfma_f32_32x32x16_bf16 a[64:79], a[116:119], v[172:175], a[64:79]
    s_setpc_b64 s[66:67]
L_slow0a:
    s_nop 15
    s_nop 7
    v_max3_f32 v2, v48, v49, v50
    v_max3_f32 v2, v2, v51, v52
    v_max3_f32 v2, v2, v53, v54
    v_max3_f32 v2, v2, v55, v56
    v_max3_f32 v2, v2, v57, v58
    v_max3_f32 v2, v2, v59, v60
    v_max3_f32 v2, v2, v61, v62
    v_max_f32 v2, v2, v63
    v_mov_b32 v3, v2
    s_nop 1
    v_permlane32_swap_b32 v2, v3
    v_max_f32 v2, v2, v3
    v_max_f32 v2, 0, v2
    v_sub_f32 v3, 0, v2
    v_exp_f32 v3, v3
    s_nop 0
    v_mul_f32 v36, v36, v3
    v_mul_f32 v176, v176, v3
    v_mul_f32 v177, v177, v3
    v_mul_f32 v178, v178, v3
    v_mul_f32 v179, v179, v3
    v_mul_f32 v180, v180, v3
    v_mul_f32 v181, v181, v3
    v_mul_f32 v182, v182, v3
    v_mul_f32 v183, v183, v3
    v_mul_f32 v184, v184, v3
    v_mul_f32 v185, v185, v3
    v_mul_f32 v186, v186, v3
    v_mul_f32 v187, v187, v3
    v_mul_f32 v188, v188, v3
    v_mul_f32 v189, v189, v3
    v_mul_f32 v190, v190, v3
    v_mul_f32 v191, v191, v3
    v_mul_f32 v192, v192, v3
    v_mul_f32 v193, v193, v3
    v_mul_f32 v194, v194, v3
    v_mul_f32 v195, v195, v3
    v_mul_f32 v196, v196, v3
    v_mul_f32 v197, v197, v3
    v_mul_f32 v198, v198, v3
    v_mul_f32 v199, v199, v3
    v_mul_f32 v200, v200, v3
    v_mul_f32 v201, v201, v3
    v_mul_f32 v202, v202, v3
    v_mul_f32 v203, v203, v3
    v_mul_f32 v204, v204, v3
    v_mul_f32 v205, v205, v3
    v_mul_f32 v206, v206, v3
    v_mul_f32 v207, v207, v3
    v_mul_f32 v208, v208, v3
    v_mul_f32 v209, v209, v3
    v_mul_f32 v210, v210, v3
    v_mul_f32 v211, v211, v3
    v_mul_f32 v212, v212, v3
    v_mul_f32 v213, v213, v3
    v_mul_f32 v214, v214, v3
    v_mul_f32 v215, v215, v3
    v_mul_f32 v216, v216, v3
    v_mul_f32 v217, v217, v3
    v_mul_f32 v218, v218, v3
    v_mul_f32 v219, v219, v3
    v_mul_f32 v220, v220, v3
    v_mul_f32 v221, v221, v3
    v_mul_f32 v222, v222, v3
    v_mul_f32 v223, v223, v3
    v_mul_f32 v224, v224, v3
    v_mul_f32 v225, v225, v3
    v_mul_f32 v226, v226, v3
    v_mul_f32 v227, v227, v3
    v_mul_f32 v228, v228, v3
    v_mul_f32 v229, v229, v3
    v_mul_f32 v230, v230, v3
    v_mul_f32 v231, v231, v3
    v_mul_f32 v232, v232, v3
    v_mul_f32 v233, v233, v3
    v_mul_f32 v234, v234, v3
    v_mul_f32 v235, v235, v3
    v_mul_f32 v236, v236, v3
    v_mul_f32 v237, v237, v3
    v_mul_f32 v238, v238, v3
    v_mul_f32 v239, v239, v3
    v_sub_f32 v80, v80, v2
    v_sub_f32 v81, v81, v2
    v_sub_f32 v82, v82, v2
    v_sub_f32 v83, v83, v2
    v_sub_f32 v84, v84, v2
    v_sub_f32 v85, v85, v2
    v_sub_f32 v86, v86, v2
    v_sub_f32 v87, v87, v2
    v_sub_f32 v88, v88, v2
    v_sub_f32 v89, v89, v2
    v_sub_f32 v90, v90, v2
    v_sub_f32 v91, v91, v2
    v_sub_f32 v92, v92, v2
    v_sub_f32 v93, v93, v2
    v_sub_f32 v94, v94, v2
    v_sub_f32 v95, v95, v2
    v_sub_f32 v48, v48, v2
    v_sub_f32 v49, v49, v2
    v_sub_f32 v50, v50, v2
    v_sub_f32 v51, v51, v2
    v_sub_f32 v52, v52, v2
    v_sub_f32 v53, v53, v2
    v_sub_f32 v54, v54, v2
    v_sub_f32 v55, v55, v2
    v_sub_f32 v56, v56, v2
    v_sub_f32 v57, v57, v2
    v_sub_f32 v58, v58, v2
    v_sub_f32 v59, v59, v2
    v_sub_f32 v60, v60, v2
    v_sub_f32 v61, v61, v2
    v_sub_f32 v62, v62, v2
    v_sub_f32 v63, v63, v2
    v_sub_f32 v64, v64, v2
    v_sub_f32 v65, v65, v2
    v_sub_f32 v66, v66, v2
    v_sub_f32 v67, v67, v2
    v_sub_f32 v68, v68, v2
    v_sub_f32 v69, v69, v2
    v_sub_f32 v70, v70, v2
    v_sub_f32 v71, v71, v2
    v_sub_f32 v72, v72, v2
    v_sub_f32 v73, v73, v2
    v_sub_f32 v74, v74, v2
    v_sub_f32 v75, v75, v2
    v_sub_f32 v76, v76, v2
    v_sub_f32 v77, v77, v2
    v_sub_f32 v78, v78, v2
    v_sub_f32 v79, v79, v2
    v_exp_f32 v240, v48
    v_exp_f32 v241, v49
    v_exp_f32 v242, v50
    v_exp_f32 v243, v51
    v_add_f32 v37, v240, v241
    v_add_f32 v38, v242, v243
    v_cvt_pk_bf16_f32 v96, v240, v241
    v_cvt_pk_bf16_f32 v97, v242, v243
    v_exp_f32 v244, v52
    v_exp_f32 v245, v53
    v_exp_f32 v246, v54
    v_exp_f32 v247, v55
    v_add_f32 v37, v37, v244
    v_add_f32 v38, v38, v246
    v_add_f32 v37, v37, v245
    v_add_f32 v38, v38, v247
    v_cvt_pk_bf16_f32 v98, v244, v245
    v_cvt_pk_bf16_f32 v99, v246, v247
    v_exp_f32 v248, v56
    v_exp_f32 v249, v57
    v_exp_f32 v250, v58
    v_exp_f32 v251, v59
    v_add_f32 v37, v37, v248
    v_add_f32 v38, v38, v250
    v_add_f32 v37, v37, v249
    v_add_f32 v38, v38, v251
    v_cvt_pk_bf16_f32 v100, v248, v249
    v_cvt_pk_bf16_f32 v101, v250, v251
    v_exp_f32 v252, v60
    v_exp_f32 v253, v61
    v_exp_f32 v254, v62
    v_exp_f32 v255, v63
    v_add_f32 v37, v37, v252
    v_add_f32 v38, v38, v254
    v_add_f32 v37, v37, v253
    v_add_f32 v38, v38, v255
    v_cvt_pk_bf16_f32 v102, v252, v253
    v_cvt_pk_bf16_f32 v103, v254, v255
    v_add_f32 v37, v37, v38
    s_nop 1
    s_branch L_cont0a
L_slow1a:
    s_nop 15
    s_nop 7
    v_max3_f32 v2, v64, v65, v66
    v_max3_f32 v2, v2, v67, v68
    v_max3_f32 v2, v2, v69, v70
    v_max3_f32 v2, v2, v71, v72
    v_max3_f32 v2, v2, v73, v74
    v_max3_f32 v2, v2, v75, v76
    v_max3_f32 v2, v2, v77, v78
    v_max_f32 v2, v2, v79
    v_mov_b32 v3, v2
    s_nop 1
    v_permlane32_swap_b32 v2, v3
    v_max_f32 v2, v2, v3
    v_max_f32 v2, 0, v2
    v_sub_f32 v3, 0, v2
    v_exp_f32 v3, v3
    s_nop 0
    v_mul_f32 v36, v36, v3
    v_mul_f32 v176, v176, v3
    v_mul_f32 v177, v177, v3
    v_mul_f32 v178, v178, v3
    v_mul_f32 v179, v179, v3
    v_mul_f32 v180, v180, v3
    v_mul_f32 v181, v181, v3
    v_mul_f32 v182, v182, v3
    v_mul_f32 v183, v183, v3
    v_mul_f32 v184, v184, v3
    v_mul_f32 v185, v185, v3
    v_mul_f32 v186, v186, v3
    v_mul_f32 v187, v187, v3
    v_mul_f32 v188, v188, v3
    v_mul_f32 v189, v189, v3
    v_mul_f32 v190, v190, v3
    v_mul_f32 v191, v191, v3
    v_mul_f32 v192, v192, v3
    v_mul_f32 v193, v193, v3
    v_mul_f32 v194, v194, v3
    v_mul_f32 v195, v195, v3
    v_mul_f32 v196, v196, v3
    v_mul_f32 v197, v197, v3
    v_mul_f32 v198, v198, v3
    v_mul_f32 v199, v199, v3
    v_mul_f32 v200, v200, v3
    v_mul_f32 v201, v201, v3
    v_mul_f32 v202, v202, v3
    v_mul_f32 v203, v203, v3
    v_mul_f32 v204, v204, v3
    v_mul_f32 v205, v205, v3
    v_mul_f32 v206, v206, v3
    v_mul_f32 v207, v207, v3
    v_mul_f32 v208, v208, v3
    v_mul_f32 v209, v209, v3
    v_mul_f32 v210, v210, v3
    v_mul_f32 v211, v211, v3
    v_mul_f32 v212, v212, v3
    v_mul_f32 v213, v213, v3
    v_mul_f32 v214, v214, v3
    v_mul_f32 v215, v215, v3
    v_mul_f32 v216, v216, v3
    v_mul_f32 v217, v217, v3
    v_mul_f32 v218, v218, v3
    v_mul_f32 v219, v219, v3
    v_mul_f32 v220, v220, v3
    v_mul_f32 v221, v221, v3
    v_mul_f32 v222, v222, v3
    v_mul_f32 v223, v223, v3
    v_mul_f32 v224, v224, v3
    v_mul_f32 v225, v225, v3
    v_mul_f32 v226, v226, v3
    v_mul_f32 v227, v227, v3
    v_mul_f32 v228, v228, v3
    v_mul_f32 v229, v229, v3
    v_mul_f32 v230, v230, v3
    v_mul_f32 v231, v231, v3
    v_mul_f32 v232, v232, v3
    v_mul_f32 v233, v233, v3
    v_mul_f32 v234, v234, v3
    v_mul_f32 v235, v235, v3
    v_mul_f32 v236, v236, v3
    v_mul_f32 v237, v237, v3
    v_mul_f32 v238, v238, v3
    v_mul_f32 v239, v239, v3
    v_sub_f32 v80, v80, v2
    v_sub_f32 v81, v81, v2
    v_sub_f32 v82, v82, v2
    v_sub_f32 v83, v83, v2
    v_sub_f32 v84, v84, v2
    v_sub_f32 v85, v85, v2
    v_sub_f32 v86, v86, v2
    v_sub_f32 v87, v87, v2
    v_sub_f32 v88, v88, v2
    v_sub_f32 v89, v89, v2
    v_sub_f32 v90, v90, v2
    v_sub_f32 v91, v91, v2
    v_sub_f32 v92, v92, v2
    v_sub_f32 v93, v93, v2
    v_sub_f32 v94, v94, v2
    v_sub_f32 v95, v95, v2
    v_sub_f32 v64, v64, v2
    v_sub_f32 v65, v65, v2
    v_sub_f32 v66, v66, v2
    v_sub_f32 v67, v67, v2
    v_sub_f32 v68, v68, v2
    v_sub_f32 v69, v69, v2
    v_sub_f32 v70, v70, v2
    v_sub_f32 v71, v71, v2
    v_sub_f32 v72, v72, v2
    v_sub_f32 v73, v73, v2
    v_sub_f32 v74, v74, v2
    v_sub_f32 v75, v75, v2
    v_sub_f32 v76, v76, v2
    v_sub_f32 v77, v77, v2
    v_sub_f32 v78, v78, v2
    v_sub_f32 v79, v79, v2
    v_sub_f32 v48, v48, v2
    v_sub_f32 v49, v49, v2
    v_sub_f32 v50, v50, v2
    v_sub_f32 v51, v51, v2
    v_sub_f32 v52, v52, v2
    v_sub_f32 v53, v53, v2
    v_sub_f32 v54, v54, v2
    v_sub_f32 v55, v55, v2
    v_sub_f32 v56, v56, v2
    v_sub_f32 v57, v57, v2
    v_sub_f32 v58, v58, v2
    v_sub_f32 v59, v59, v2
    v_sub_f32 v60, v60, v2
    v_sub_f32 v61, v61, v2
    v_sub_f32 v62, v62, v2
    v_sub_f32 v63, v63, v2
    v_exp_f32 v240, v64
    v_exp_f32 v241, v65
    v_exp_f32 v242, v66
    v_exp_f32 v243, v67
    v_add_f32 v37, v240, v241
    v_add_f32 v38, v242, v243
    v_cvt_pk_bf16_f32 v104, v240, v241
    v_cvt_pk_bf16_f32 v105, v242, v243
    v_exp_f32 v244, v68
    v_exp_f32 v245, v69
    v_exp_f32 v246, v70
    v_exp_f32 v247, v71
    v_add_f32 v37, v37, v244
    v_add_f32 v38, v38, v246
    v_add_f32 v37, v37, v245
    v_add_f32 v38, v38, v247
    v_cvt_pk_bf16_f32 v106, v244, v245
    v_cvt_pk_bf16_f32 v107, v246, v247
    v_exp_f32 v248, v72
    v_exp_f32 v249, v73
    v_exp_f32 v250, v74
    v_exp_f32 v251, v75
    v_add_f32 v37, v37, v248
    v_add_f32 v38, v38, v250
    v_add_f32 v37, v37, v249
    v_add_f32 v38, v38, v251
    v_cvt_pk_bf16_f32 v108, v248, v249
    v_cvt_pk_bf16_f32 v109, v250, v251
    v_exp_f32 v252, v76
    v_exp_f32 v253, v77
    v_exp_f32 v254, v78
    v_exp_f32 v255, v79
    v_add_f32 v37, v37, v252
    v_add_f32 v38, v38, v254
    v_add_f32 v37, v37, v253
    v_add_f32 v38, v38, v255
    v_cvt_pk_bf16_f32 v110, v252, v253
    v_cvt_pk_bf16_f32 v111, v254, v255
    v_add_f32 v37, v37, v38
    s_nop 1
    s_branch L_cont1a
L_slow0b:
    s_nop 15
    s_nop 7
    v_max3_f32 v2, v48, v49, v50
    v_max3_f32 v2, v2, v51, v52
    v_max3_f32 v2, v2, v53, v54
    v_max3_f32 v2, v2, v55, v56
    v_max3_f32 v2, v2, v57, v58
    v_max3_f32 v2, v2, v59, v60
    v_max3_f32 v2, v2, v61, v62
    v_max_f32 v2, v2, v63
    v_mov_b32 v3, v2
    s_nop 1
    v_permlane32_swap_b32 v2, v3
    v_max_f32 v2, v2, v3
    v_max_f32 v2, 0, v2
    v_sub_f32 v3, 0, v2
    v_exp_f32 v3, v3
    s_nop 0
    v_mul_f32 v36, v36, v3
    v_mul_f32 v176, v176, v3
    v_mul_f32 v177, v177, v3
    v_mul_f32 v178, v178, v3
    v_mul_f32 v179, v179, v3
    v_mul_f32 v180, v180, v3
    v_mul_f32 v181, v181, v3
    v_mul_f32 v182, v182, v3
    v_mul_f32 v183, v183, v3
    v_mul_f32 v184, v184, v3
    v_mul_f32 v185, v185, v3
    v_mul_f32 v186, v186, v3
    v_mul_f32 v187, v187, v3
    v_mul_f32 v188, v188, v3
    v_mul_f32 v189, v189, v3
    v_mul_f32 v190, v190, v3
    v_mul_f32 v191, v191, v3
    v_mul_f32 v192, v192, v3
    v_mul_f32 v193, v193, v3
    v_mul_f32 v194, v194, v3
    v_mul_f32 v195, v195, v3
    v_mul_f32 v196, v196, v3
    v_mul_f32 v197, v197, v3
    v_mul_f32 v198, v198, v3
    v_mul_f32 v199, v199, v3
    v_mul_f32 v200, v200, v3
    v_mul_f32 v201, v201, v3
    v_mul_f32 v202, v202, v3
    v_mul_f32 v203, v203, v3
    v_mul_f32 v204, v204, v3
    v_mul_f32 v205, v205, v3
    v_mul_f32 v206, v206, v3
    v_mul_f32 v207, v207, v3
    v_mul_f32 v208, v208, v3
    v_mul_f32 v209, v209, v3
    v_mul_f32 v210, v210, v3
    v_mul_f32 v211, v211, v3
    v_mul_f32 v212, v212, v3
    v_mul_f32 v213, v213, v3
    v_mul_f32 v214, v214, v3
    v_mul_f32 v215, v215, v3
    v_mul_f32 v216, v216, v3
    v_mul_f32 v217, v217, v3
    v_mul_f32 v218, v218, v3
    v_mul_f32 v219, v219, v3
    v_mul_f32 v220, v220, v3
    v_mul_f32 v221, v221, v3
    v_mul_f32 v222, v222, v3
    v_mul_f32 v223, v223, v3
    v_mul_f32 v224, v224, v3
    v_mul_f32 v225, v225, v3
    v_mul_f32 v226, v226, v3
    v_mul_f32 v227, v227, v3
    v_mul_f32 v228, v228, v3
    v_mul_f32 v229, v229, v3
    v_mul_f32 v230, v230, v3
    v_mul_f32 v231, v231, v3
    v_mul_f32 v232, v232, v3
    v_mul_f32 v233, v233, v3
    v_mul_f32 v234, v234, v3
    v_mul_f32 v235, v235, v3
    v_mul_f32 v236, v236, v3
    v_mul_f32 v237, v237, v3
    v_mul_f32 v238, v238, v3
    v_mul_f32 v239, v239, v3
    v_sub_f32 v80, v80, v2
    v_sub_f32 v81, v81, v2
    v_sub_f32 v82, v82, v2
    v_sub_f32 v83, v83, v2
    v_sub_f32 v84, v84, v2
    v_sub_f32 v85, v85, v2
    v_sub_f32 v86, v86, v2
    v_sub_f32 v87, v87, v2
    v_sub_f32 v88, v88, v2
    v_sub_f32 v89, v89, v2
    v_sub_f32 v90, v90, v2
    v_sub_f32 v91, v91, v2
    v_sub_f32 v92, v92, v2
    v_sub_f32 v93, v93, v2
    v_sub_f32 v94, v94, v2
    v_sub_f32 v95, v95, v2
    v_sub_f32 v48, v48, v2
    v_sub_f32 v49, v49, v2
    v_sub_f32 v50, v50, v2
    v_sub_f32 v51, v51, v2
    v_sub_f32 v52, v52, v2
    v_sub_f32 v53, v53, v2
    v_sub_f32 v54, v54, v2
    v_sub_f32 v55, v55, v2
    v_sub_f32 v56, v56, v2
    v_sub_f32 v57, v57, v2
    v_sub_f32 v58, v58, v2
    v_sub_f32 v59, v59, v2
    v_sub_f32 v60, v60, v2
    v_sub_f32 v61, v61, v2
    v_sub_f32 v62, v62, v2
    v_sub_f32 v63, v63, v2
    v_sub_f32 v64, v64, v2
    v_sub_f32 v65, v65, v2
    v_sub_f32 v66, v66, v2
    v_sub_f32 v67, v67, v2
    v_sub_f32 v68, v68, v2
    v_sub_f32 v69, v69, v2
    v_sub_f32 v70, v70, v2
    v_sub_f32 v71, v71, v2
    v_sub_f32 v72, v72, v2
    v_sub_f32 v73, v73, v2
    v_sub_f32 v74, v74, v2
    v_sub_f32 v75, v75, v2
    v_sub_f32 v76, v76, v2
    v_sub_f32 v77, v77, v2
    v_sub_f32 v78, v78, v2
    v_sub_f32 v79, v79, v2
    v_exp_f32 v240, v48
    v_exp_f32 v241, v49
    v_exp_f32 v242, v50
    v_exp_f32 v243, v51
    v_add_f32 v37, v240, v241
    v_add_f32 v38, v242, v243
    v_cvt_pk_bf16_f32 v96, v240, v241
    v_cvt_pk_bf16_f32 v97, v242, v243
    v_exp_f32 v244, v52
    v_exp_f32 v245, v53
    v_exp_f32 v246, v54
    v_exp_f32 v247, v55
    v_add_f32 v37, v37, v244
    v_add_f32 v38, v38, v246
    v_add_f32 v37, v37, v245
    v_add_f32 v38, v38, v247
    v_cvt_pk_bf16_f32 v98, v244, v245
    v_cvt_pk_bf16_f32 v99, v246, v247
    v_exp_f32 v248, v56
    v_exp_f32 v249, v57
    v_exp_f32 v250, v58
    v_exp_f32 v251, v59
    v_add_f32 v37, v37, v248
    v_add_f32 v38, v38, v250
    v_add_f32 v37, v37, v249
    v_add_f32 v38, v38, v251
    v_cvt_pk_bf16_f32 v100, v248, v249
    v_cvt_pk_bf16_f32 v101, v250, v251
    v_exp_f32 v252, v60
    v_exp_f32 v253, v61
    v_exp_f32 v254, v62
    v_exp_f32 v255, v63
    v_add_f32 v37, v37, v252
    v_add_f32 v38, v38, v254
    v_add_f32 v37, v37, v253
    v_add_f32 v38, v38, v255
    v_cvt_pk_bf16_f32 v102, v252, v253
    v_cvt_pk_bf16_f32 v103, v254, v255
    v_add_f32 v37, v37, v38
    s_nop 1
    s_branch L_cont0b
L_slow1b:
    s_nop 15
    s_nop 7
    v_max3_f32 v2, v64, v65, v66
    v_max3_f32 v2, v2, v67, v68
    v_max3_f32 v2, v2, v69, v70
    v_max3_f32 v2, v2, v71, v72
    v_max3_f32 v2, v2, v73, v74
    v_max3_f32 v2, v2, v75, v76
    v_max3_f32 v2, v2, v77, v78
    v_max_f32 v2, v2, v79
    v_mov_b32 v3, v2
    s_nop 1
    v_permlane32_swap_b32 v2, v3
    v_max_f32 v2, v2, v3
    v_max_f32 v2, 0, v2
    v_sub_f32 v3, 0, v2
    v_exp_f32 v3, v3
    s_nop 0
    v_mul_f32 v36, v36, v3
    v_mul_f32 v176, v176, v3
    v_mul_f32 v177, v177, v3
    v_mul_f32 v178, v178, v3
    v_mul_f32 v179, v179, v3
    v_mul_f32 v180, v180, v3
    v_mul_f32 v181, v181, v3
    v_mul_f32 v182, v182, v3
    v_mul_f32 v183, v183, v3
    v_mul_f32 v184, v184, v3
    v_mul_f32 v185, v185, v3
    v_mul_f32 v186, v186, v3
    v_mul_f32 v187, v187, v3
    v_mul_f32 v188, v188, v3
    v_mul_f32 v189, v189, v3
    v_mul_f32 v190, v190, v3
    v_mul_f32 v191, v191, v3
    v_mul_f32 v192, v192, v3
    v_mul_f32 v193, v193, v3
    v_mul_f32 v194, v194, v3
    v_mul_f32 v195, v195, v3
    v_mul_f32 v196, v196, v3
    v_mul_f32 v197, v197, v3
    v_mul_f32 v198, v198, v3
    v_mul_f32 v199, v199, v3
    v_mul_f32 v200, v200, v3
    v_mul_f32 v201, v201, v3
    v_mul_f32 v202, v202, v3
    v_mul_f32 v203, v203, v3
    v_mul_f32 v204, v204, v3
    v_mul_f32 v205, v205, v3
    v_mul_f32 v206, v206, v3
    v_mul_f32 v207, v207, v3
    v_mul_f32 v208, v208, v3
    v_mul_f32 v209, v209, v3
    v_mul_f32 v210, v210, v3
    v_mul_f32 v211, v211, v3
    v_mul_f32 v212, v212, v3
    v_mul_f32 v213, v213, v3
    v_mul_f32 v214, v214, v3
    v_mul_f32 v215, v215, v3
    v_mul_f32 v216, v216, v3
    v_mul_f32 v217, v217, v3
    v_mul_f32 v218, v218, v3
    v_mul_f32 v219, v219, v3
    v_mul_f32 v220, v220, v3
    v_mul_f32 v221, v221, v3
    v_mul_f32 v222, v222, v3
    v_mul_f32 v223, v223, v3
    v_mul_f32 v224, v224, v3
    v_mul_f32 v225, v225, v3
    v_mul_f32 v226, v226, v3
    v_mul_f32 v227, v227, v3
    v_mul_f32 v228, v228, v3
    v_mul_f32 v229, v229, v3
    v_mul_f32 v230, v230, v3
    v_mul_f32 v231, v231, v3
    v_mul_f32 v232, v232, v3
    v_mul_f32 v233, v233, v3
    v_mul_f32 v234, v234, v3
    v_mul_f32 v235, v235, v3
    v_mul_f32 v236, v236, v3
    v_mul_f32 v237, v237, v3
    v_mul_f32 v238, v238, v3
    v_mul_f32 v239, v239, v3
    v_sub_f32 v80, v80, v2
    v_sub_f32 v81, v81, v2
    v_sub_f32 v82, v82, v2
    v_sub_f32 v83, v83, v2
    v_sub_f32 v84, v84, v2
    v_sub_f32 v85, v85, v2
    v_sub_f32 v86, v86, v2
    v_sub_f32 v87, v87, v2
    v_sub_f32 v88, v88, v2
    v_sub_f32 v89, v89, v2
    v_sub_f32 v90, v90, v2
    v_sub_f32 v91, v91, v2
    v_sub_f32 v92, v92, v2
    v_sub_f32 v93, v93, v2
    v_sub_f32 v94, v94, v2
    v_sub_f32 v95, v95, v2
    v_sub_f32 v64, v64, v2
    v_sub_f32 v65, v65, v2
    v_sub_f32 v66, v66, v2
    v_sub_f32 v67, v67, v2
    v_sub_f32 v68, v68, v2
    v_sub_f32 v69, v69, v2
    v_sub_f32 v70, v70, v2
    v_sub_f32 v71, v71, v2
    v_sub_f32 v72, v72, v2
    v_sub_f32 v73, v73, v2
    v_sub_f32 v74, v74, v2
    v_sub_f32 v75, v75, v2
    v_sub_f32 v76, v76, v2
    v_sub_f32 v77, v77, v2
    v_sub_f32 v78, v78, v2
    v_sub_f32 v79, v79, v2
    v_sub_f32 v48, v48, v2
    v_sub_f32 v49, v49, v2
    v_sub_f32 v50, v50, v2
    v_sub_f32 v51, v51, v2
    v_sub_f32 v52, v52, v2
    v_sub_f32 v53, v53, v2
    v_sub_f32 v54, v54, v2
    v_sub_f32 v55, v55, v2
    v_sub_f32 v56, v56, v2
    v_sub_f32 v57, v57, v2
    v_sub_f32 v58, v58, v2
    v_sub_f32 v59, v59, v2
    v_sub_f32 v60, v60, v2
    v_sub_f32 v61, v61, v2
    v_sub_f32 v62, v62, v2
    v_sub_f32 v63, v63, v2
    v_exp_f32 v240, v64
    v_exp_f32 v241, v65
    v_exp_f32 v242, v66
    v_exp_f32 v243, v67
    v_add_f32 v37, v240, v241
    v_add_f32 v38, v242, v243
    v_cvt_pk_bf16_f32 v104, v240, v241
    v_cvt_pk_bf16_f32 v105, v242, v243
    v_exp_f32 v244, v68
    v_exp_f32 v245, v69
    v_exp_f32 v246, v70
    v_exp_f32 v247, v71
    v_add_f32 v37, v37, v244
    v_add_f32 v38, v38, v246
    v_add_f32 v37, v37, v245
    v_add_f32 v38, v38, v247
    v_cvt_pk_bf16_f32 v106, v244, v245
    v_cvt_pk_bf16_f32 v107, v246, v247
    v_exp_f32 v248, v72
    v_exp_f32 v249, v73
    v_exp_f32 v250, v74
    v_exp_f32 v251, v75
    v_add_f32 v37, v37, v248
    v_add_f32 v38, v38, v250
    v_add_f32 v37, v37, v249
    v_add_f32 v38, v38, v251
    v_cvt_pk_bf16_f32 v108, v248, v249
    v_cvt_pk_bf16_f32 v109, v250, v251
    v_exp_f32 v252, v76
    v_exp_f32 v253, v77
    v_exp_f32 v254, v78
    v_exp_f32 v255, v79
    v_add_f32 v37, v37, v252
    v_add_f32 v38, v38, v254
    v_add_f32 v37, v37, v253
    v_add_f32 v38, v38, v255
    v_cvt_pk_bf16_f32 v110, v252, v253
    v_cvt_pk_bf16_f32 v111, v254, v255
    v_add_f32 v37, v37, v38
    s_nop 1
    s_branch L_cont1b
L_END:
    s_endpgm
.section .rodata,"a"
.p2align 6
.amdhsa_kernel concat_heads__mha_block_cached__mha_block_cached__near_ridge_kernel
  .amdhsa_next_free_vgpr 512
  .amdhsa_next_free_sgpr 102
  .amdhsa_accum_offset 256
  .amdhsa_group_segment_fixed_size 0
  .amdhsa_kernarg_size 104
  .amdhsa_user_sgpr_count 2
  .amdhsa_user_sgpr_kernarg_segment_ptr 1
  .amdhsa_system_sgpr_workgroup_id_x 1
.end_amdhsa_kernel
```
